```python
import torch

def _softmax(x, axis=-1):
    return torch.softmax(x, dim=axis)
def _gelu(x):
    return torch.nn.functional.gelu(x, approximate="tanh")
def _silu(x):
    return torch.nn.functional.silu(x)
def _sigmoid(x):
    return torch.sigmoid(x)
def _layernorm(x, axis=-1, eps=1e-5):
    m = x.mean(dim=axis, keepdim=True)
    v = x.var(dim=axis, keepdim=True, unbiased=False)
    return (x - m) / torch.sqrt(v + eps)
def _scatter_add(tgt, idx, src, axis=0):
    return tgt.clone().index_add_(axis, idx, src)
def _segment_sum(src, seg, n):
    out = torch.zeros((n,) + src.shape[1:], dtype=src.dtype)
    return out.index_add_(0, seg, src)
def _pad(x, pw):
    flat = tuple(v for pair in reversed(pw) for v in pair)
    return torch.nn.functional.pad(x, flat)

kernel_name = 'sequential_preLN__sliding_block_cached__moe_arch_mod__decode'

def setup_inputs():

    _w = (lambda a: (lambda t: t.to(torch.bfloat16) if t.is_floating_point() else t)(torch.as_tensor(a)))
    def _A_setup():
        B, Sq, D = 1, 1, 576
        Hq, Hkv, Sk, Dh = 32, 16, 65536, 128
        assert Hq % Hkv == 0, (Hq, Hkv)
        return {
            "x": _w((lambda *s: torch.randn(*s, dtype=torch.bfloat16) * 0.05)(B, Sq, D)),
            "k_cache": _w((lambda *s: torch.randn(*s, dtype=torch.bfloat16) * 3.2)(B, Hkv, Sk, Dh)),
            "v_cache": _w((lambda *s: torch.randn(*s, dtype=torch.bfloat16) * 0.4)(B, Hkv, Sk, Dh)),
            "wq": _w((lambda *s: torch.randn(*s, dtype=torch.bfloat16) * 3.2)(D, Hq * Dh) * (D ** -0.5)),
            "wo": _w((lambda *s: torch.randn(*s, dtype=torch.bfloat16) * 0.4)(Hq * Dh, D) * ((Hq * Dh) ** -0.5)),
        }
    _A_in = _A_setup()

    def _B_setup():
        B, S, D, F, C = 1, 1, 576, 4608, 1
        return {
            "x": _w((lambda *s: torch.randn(*s, dtype=torch.bfloat16) * 0.05)(B, S, D)),
            "w_r": _w((lambda *s: torch.randn(*s, dtype=torch.bfloat16) * 0.05)(D)),
            "w_gate": _w((lambda *s: torch.randn(*s, dtype=torch.bfloat16) * 0.05)(D, F)),
            "w_up": _w((lambda *s: torch.randn(*s, dtype=torch.bfloat16) * 0.05)(D, F)),
            "w_down": _w((lambda *s: torch.randn(*s, dtype=torch.bfloat16) * 0.05)(F, D)),
        }
    _B_in = _B_setup()

    return {
        "A_x": _A_in["x"],
        "A_k_cache": _A_in["k_cache"],
        "A_v_cache": _A_in["v_cache"],
        "A_wq": _A_in["wq"],
        "A_wo": _A_in["wo"],
        "B_x": _B_in["x"],
        "B_w_r": _B_in["w_r"],
        "B_w_gate": _B_in["w_gate"],
        "B_w_up": _B_in["w_up"],
        "B_w_down": _B_in["w_down"],
    }

def reference(A_x, A_k_cache, A_v_cache, A_wq, A_wo, B_x, B_w_r, B_w_gate, B_w_up, B_w_down):
    def _A_ref(x, k_cache, v_cache, wq, wo):
        B, Sq, D = x.shape
        Hq, Dh = 32, 128
        Hkv, Sk = k_cache.shape[1], k_cache.shape[2]
        W = min(4096, max(256, Sk // 4))
        rep = Hq // Hkv
        q = (lambda x, *d: x.permute(*d))((x @ wq).reshape(B, Sq, Hq, Dh), 0, 2, 1, 3)
        k = (lambda x, n, axis: torch.repeat_interleave(x, n, dim=axis))(k_cache[:, :, Sk - W:, :], rep, axis=1)
        v = (lambda x, n, axis: torch.repeat_interleave(x, n, dim=axis))(v_cache[:, :, Sk - W:, :], rep, axis=1)
        scores = torch.einsum("bhqd,bhkd->bhqk", q, k) * (Dh ** -0.5)
        p = _softmax(scores, axis=-1)
        o = torch.einsum("bhqk,bhkd->bhqd", p, v)
        return (lambda x, *d: x.permute(*d))(o, 0, 2, 1, 3).reshape(B, Sq, Hq * Dh) @ wo

    def _B_ref(x, w_r, w_gate, w_up, w_down):
        B, S, D = x.shape
        C = 1
        r = x @ w_r
        idx = torch.argsort(-r, axis=-1)[:, :C]
        idx_e = (lambda x, n, axis: torch.repeat_interleave(x, n, dim=axis))(idx.reshape(B, C, 1), D, axis=2)
        x_sel = (lambda x, i, axis: torch.take_along_dim(x, i, dim=axis))(x, idx_e, axis=1)
        g = _silu(x_sel @ w_gate)
        u = x_sel @ w_up
        y = (g * u) @ w_down
        r_sel = _sigmoid((lambda x, i, axis: torch.take_along_dim(x, i, dim=axis))(r, idx, axis=1))
        y = y * r_sel.reshape(B, C, 1)
        b_off = (torch.arange(B) * S).reshape(B, 1)
        flat_idx = (idx + b_off).reshape(B * C)
        zero = (x * 0.0).reshape(B * S, D)
        upd = _scatter_add(zero, flat_idx, y.reshape(B * C, D), axis=0)
        return x + upd.reshape(B, S, D)

    x = A_x
    h = x + _A_ref(_layernorm(x, axis=-1), A_k_cache, A_v_cache, A_wq, A_wo)
    h2 = h + _B_ref(_layernorm(h, axis=-1), B_w_r, B_w_gate, B_w_up, B_w_down)
    return h2
```

```asm
; @launch grid=(256,1,1) block=(960,1,1) lds=159744
.amdgcn_target "amdgcn-amd-amdhsa--gfx950"
.text
.globl sequential_preLN__sliding_block_cached__moe_arch_mod__decode_kernel
.p2align 8
.type sequential_preLN__sliding_block_cached__moe_arch_mod__decode_kernel,@function
sequential_preLN__sliding_block_cached__moe_arch_mod__decode_kernel:
    s_cmp_ge_u32 s2, 256
    s_cbranch_scc1 Lend
    s_load_dwordx8 s[8:15], s[0:1], 0
    s_load_dwordx2 s[30:31], s[0:1], 96
    s_load_dwordx2 s[16:17], s[0:1], 32
    s_load_dwordx8 s[20:27], s[0:1], 48
    s_load_dwordx2 s[28:29], s[0:1], 80
    v_and_b32 v1, 63, v0
    s_getpc_b64 s[52:53]
Lpc0:
    s_sub_u32 s52, s52, Lpc0-sequential_preLN__sliding_block_cached__moe_arch_mod__decode_kernel
    s_subb_u32 s53, s53, 0
    s_mov_b32 s54, Lend-sequential_preLN__sliding_block_cached__moe_arch_mod__decode_kernel
    s_mov_b32 s55, 0x20000
    s_lshr_b32 s79, s2, 3
    s_lshl_b32 s79, s79, 10
    v_lshlrev_b32 v5, 7, v0
    v_cmp_gt_u32 vcc, 8, v0
    s_and_saveexec_b64 s[88:89], vcc
    s_cbranch_execz Lncp0
    buffer_load_dword v20, v5, s[52:55], s79 offen
Lncp0:
    s_mov_b64 exec, s[88:89]
    v_lshrrev_b32 v5, 6, v0
    s_nop 0
    v_readfirstlane_b32 s3, v5
    s_cmp_eq_u32 s3, 14
    s_cselect_b32 s3, 15, s3
    s_sub_u32 s3, s3, 1
    s_cselect_b32 s3, 13, s3
    s_add_u32 s87, s2, 0
    s_and_b32 s87, s87, 7
    s_lshr_b32 s79, s2, 3
    s_lshr_b32 s80, s79, 4
    s_lshl_b32 s4, s87, 1
    s_add_u32 s4, s4, s80
    s_and_b32 s5, s79, 15
    s_lshl_b32 s6, s4, 4
    s_add_u32 s6, s6, s5
    s_mul_i32 s82, s4, 9
    s_add_u32 s82, s82, s5
    s_mov_b32 s85, 0
    v_lshrrev_b32 v2, 3, v1
    v_and_b32 v3, 7, v1
    v_mov_b32 v4, 0
    s_sub_u32 s79, 12, s80
    s_cmp_lt_u32 s5, 9
    s_cselect_b32 s84, 0, 1
    s_cmp_lt_u32 s5, s79
    s_cselect_b32 s84, s84, 2
    s_sub_u32 s86, s5, s79
    s_lshl_b32 s80, s80, 2
    s_add_u32 s86, s86, s80
    s_lshl_b32 s81, s5, 2
    s_bitcmp1_b32 s4, 0
    s_mov_b32 s94, 0x99999999
    s_mov_b32 s95, 0x55559999
    s_cselect_b32 s94, 0x99999999, s94
    s_cselect_b32 s95, 0x56666999, s95
    s_lshr_b64 s[94:95], s[94:95], s81
    s_and_b32 s83, s94, 15
    s_bitcmp1_b32 s4, 0
    s_mov_b32 s94, 0x76543210
    s_mov_b32 s95, 0x369cba98
    s_cselect_b32 s94, 0x76543210, s94
    s_cselect_b32 s95, 0x3579ba98, s95
    s_lshr_b64 s[94:95], s[94:95], s81
    s_and_b32 s78, s94, 15
    s_lshl_b32 s78, s78, 13
    s_lshl_b32 s79, s5, 16
    s_add_u32 s78, s78, s79
    s_add_u32 s78, s78, 15728640
    s_lshl_b32 s79, s4, 24
    s_add_u32 s78, s78, s79
    s_cmp_eq_u32 s3, 13
    s_cbranch_scc0 Lcomp
    s_setprio 3
    s_mul_i32 s76, s4, 1
    s_mul_i32 s77, s5, 1
    s_add_u32 s76, s76, s77
    s_and_b32 s76, s76, 15
    s_lshl_b32 s76, s76, 12
    s_lshl_b32 s77, s83, 13
    s_cmp_ge_u32 s76, s77
    s_cselect_b32 s80, s77, 0
    s_sub_u32 s76, s76, s80
    v_bfe_u32 v12, v1, 2, 2
    v_lshrrev_b32 v13, 4, v1
    v_and_b32 v14, 3, v1
    v_lshlrev_b32 v5, 8, v12
    v_lshl_add_u32 v5, v13, 6, v5
    v_lshl_add_u32 v5, v14, 4, v5
    v_and_b32 v12, 15, v1
    v_lshlrev_b32 v15, 1, v13
    v_xor_b32 v12, v12, v15
    v_lshlrev_b32 v6, 8, v13
    v_lshl_add_u32 v6, v12, 4, v6
    v_xor_b32 v7, 128, v6
    s_waitcnt lgkmcnt(0)
    s_mov_b32 s0, 0x4000000
    s_add_u32 s36, s10, s78
    s_addc_u32 s37, s11, 0
    s_mov_b32 s38, s77
    s_mov_b32 s39, 0x20000
    s_add_u32 s40, s12, s78
    s_addc_u32 s41, s13, 0
    s_mov_b32 s42, s77
    s_mov_b32 s43, 0x20000
    s_mov_b32 m0, 12288
    s_add_u32 s79, s76, 0
    s_cmp_ge_u32 s79, s77
    s_cselect_b32 s78, s77, 0
    s_sub_u32 s79, s79, s78
    buffer_load_dwordx4 v5, s[36:39], s79 offen offset:0 nt lds
    buffer_load_dwordx4 v5, s[36:39], s79 offen offset:1024 nt lds
    buffer_load_dwordx4 v5, s[36:39], s79 offen offset:2048 nt lds
    buffer_load_dwordx4 v5, s[36:39], s79 offen offset:3072 nt lds
    s_mov_b32 m0, 16384
    s_add_u32 s79, s76, 4096
    s_cmp_ge_u32 s79, s77
    s_cselect_b32 s78, s77, 0
    s_sub_u32 s79, s79, s78
    buffer_load_dwordx4 v5, s[36:39], s79 offen offset:0 nt lds
    buffer_load_dwordx4 v5, s[36:39], s79 offen offset:1024 nt lds
    buffer_load_dwordx4 v5, s[36:39], s79 offen offset:2048 nt lds
    buffer_load_dwordx4 v5, s[36:39], s79 offen offset:3072 nt lds
    s_mov_b32 m0, 20480
    s_add_u32 s79, s76, 8192
    s_cmp_ge_u32 s79, s77
    s_cselect_b32 s78, s77, 0
    s_sub_u32 s79, s79, s78
    buffer_load_dwordx4 v5, s[36:39], s79 offen offset:0 nt lds
    buffer_load_dwordx4 v5, s[36:39], s79 offen offset:1024 nt lds
    buffer_load_dwordx4 v5, s[36:39], s79 offen offset:2048 nt lds
    buffer_load_dwordx4 v5, s[36:39], s79 offen offset:3072 nt lds
    s_mov_b32 m0, 24576
    s_add_u32 s79, s76, 12288
    s_cmp_ge_u32 s79, s77
    s_cselect_b32 s78, s77, 0
    s_sub_u32 s79, s79, s78
    buffer_load_dwordx4 v5, s[36:39], s79 offen offset:0 nt lds
    buffer_load_dwordx4 v5, s[36:39], s79 offen offset:1024 nt lds
    buffer_load_dwordx4 v5, s[36:39], s79 offen offset:2048 nt lds
    buffer_load_dwordx4 v5, s[36:39], s79 offen offset:3072 nt lds
    s_branch Lloader
Lcomp:
    v_subrev_u32 v0, 64, v0
    v_lshlrev_b32 v6, 2, v0
    v_mov_b32 v7, 0x3f803f80
    v_cmp_gt_u32 vcc, 288, v0
    s_and_saveexec_b64 s[88:89], vcc
    ds_write_b32 v6, v7 offset:3968
    v_cmp_gt_u32 vcc, 128, v0
    s_and_b64 exec, exec, vcc
    ds_write_b32 v6, v4 offset:9728
    v_cmp_gt_u32 vcc, 64, v0
    s_and_b64 exec, exec, vcc
    ds_write_b32 v6, v4
    v_mov_b32 v7, 0xf149f2ca
    v_cmp_gt_u32 vcc, 32, v0
    s_nop 1
    v_cndmask_b32 v7, 0, v7, vcc
    ds_write_b32 v6, v7 offset:768
    s_mov_b64 exec, s[88:89]
    s_lshr_b32 s90, s2, 3
    s_cmp_gt_u32 s90, 11
    s_cselect_b32 s79, 3, 0
    s_sub_u32 s79, s90, s79
    s_cmp_gt_u32 s90, 25
    s_subb_u32 s79, s79, 0
    s_mul_i32 s91, s79, 37
    s_lshr_b32 s91, s91, 8
    s_mul_i32 s80, s91, 7
    s_sub_u32 s92, s79, s80
    s_add_u32 s92, s92, 4
    s_sub_u32 s79, s90, 9
    s_cmp_lt_u32 s79, 3
    s_cselect_b32 s91, s79, s91
    s_cselect_b32 s92, 3, s92
    s_cmp_eq_u32 s90, 25
    s_cselect_b32 s91, 3, s91
    s_cselect_b32 s92, 3, s92
    s_and_b32 s92, s92, 7
    s_lshr_b32 s79, s92, 2
    s_lshl_b32 s79, s79, 4
    s_lshl_b32 s80, s87, 5
    s_add_u32 s2, s79, s80
    s_lshl_b32 s79, s91, 2
    s_add_u32 s2, s2, s79
    s_and_b32 s79, s92, 3
    s_add_u32 s2, s2, s79
    s_mul_i32 s79, s91, 144
    s_lshl_b32 s80, s3, 4
    s_add_u32 s79, s79, s80
    v_add_u32 v8, s79, v2
    s_lshl_b32 s79, s92, 7
    s_lshl_b32 s80, s87, 10
    s_add_u32 s79, s79, s80
    v_lshl_add_u32 v9, v3, 4, s79
    v_lshl_add_u32 v9, v8, 13, v9
    v_add_u32 v10, 0x10000, v9
    v_lshlrev_b32 v8, 1, v8
    v_lshlrev_b32 v11, 4, v1
    s_waitcnt lgkmcnt(0)
    s_load_dword s7, s[30:31], 0
    s_mov_b32 s0, 0x4000000
    s_mov_b32 s32, s8
    s_mov_b32 s33, s9
    s_movk_i32 s34, 1152
    s_mov_b32 s35, 0x20000
    s_mov_b32 s44, s14
    s_mov_b32 s45, s15
    s_mov_b32 s46, 4718592
    s_mov_b32 s47, 0x20000
    s_cmp_ge_u32 s3, 9
    s_cbranch_scc1 Lnowq
    buffer_load_dwordx4 v[40:43], v11, s[32:35], 0 offen
    buffer_load_dwordx4 v[44:47], v11, s[32:35], 0 offen offset:1024
    buffer_load_ushort v48, v8, s[32:35], 0 offen
    buffer_load_ushort v49, v8, s[32:35], 0 offen offset:16
    buffer_load_dwordx4 v[56:59], v9, s[44:47], 0 offen nt
    buffer_load_dwordx4 v[60:63], v10, s[44:47], 0 offen nt
Lnowq:
    s_barrier
    s_mov_b32 s48, s30
    s_mov_b32 s49, s31
    s_mov_b32 s50, 4194304
    s_mov_b32 s51, 0x20000
    s_mov_b32 s56, s20
    s_mov_b32 s57, s21
    s_movk_i32 s58, 1152
    s_mov_b32 s59, 0x20000
    s_mov_b32 s60, s28
    s_mov_b32 s61, s29
    s_movk_i32 s62, 1152
    s_mov_b32 s63, 0x20000
    s_mov_b32 s72, 0x22222222
    s_mov_b32 s73, 0x22222222
    s_mov_b32 s74, 0x44444444
    s_mov_b32 s75, 0x44444444
    s_mov_b32 s76, 0x88888888
    s_mov_b32 s77, 0x88888888
    s_cmp_lg_u32 s3, 12
    s_cbranch_scc1 Lnpt
    s_lshl_b32 s79, s6, 10
    s_add_u32 s79, s79, 1310720
    v_lshl_add_u32 v5, v1, 7, s79
    s_lshl_b32 s79, s6, 7
    s_add_u32 s79, s79, 1245184
    v_writelane_b32 v5, s79, 8
    s_lshl_b32 s79, s2, 9
    s_add_u32 s79, s79, 1052672
    v_writelane_b32 v5, s79, 9
    s_add_u32 s79, s79, 128
    v_writelane_b32 v5, s79, 10
    s_add_u32 s79, s79, 128
    v_writelane_b32 v5, s79, 11
    s_add_u32 s79, s79, 128
    v_writelane_b32 v5, s79, 12
    s_mov_b64 exec, 8191
    buffer_load_dword v20, v5, s[48:51], 0 offen sc1
    s_mov_b64 exec, -1
    s_cmp_eq_u32 s84, 1
    s_cbranch_scc1 Lnpt
    s_mul_i32 s79, s82, 2304
    s_add_u32 s79, s79, 589824
    s_mul_i32 s80, s87, 4608
    s_lshl_b32 s81, s86, 9
    s_add_u32 s80, s80, s81
    s_add_u32 s80, s80, 1572864
    s_cmp_eq_u32 s84, 0
    s_cselect_b32 s79, s79, s80
    s_cselect_b32 exec_lo, 0x3ffff, 15
    s_mov_b32 exec_hi, 0
    v_lshlrev_b32 v5, 7, v1
    buffer_load_dword v20, v5, s[48:51], s79 offen
    s_mov_b64 exec, -1
Lnpt:
    s_cmp_ge_u32 s3, 9
    s_cbranch_scc1 Lnoq
    v_and_b32 v5, 1, v1
    v_lshlrev_b32 v5, 4, v5
    v_mov_b32 v6, 0xffff
    v_lshlrev_b32 v5, v5, v6
    v_lshrrev_b32 v6, 1, v3
    v_cmp_eq_u32 vcc, 0, v6
    s_nop 1
    v_cndmask_b32 v72, 0, v5, vcc
    v_cmp_eq_u32 vcc, 1, v6
    s_nop 1
    v_cndmask_b32 v73, 0, v5, vcc
    v_cmp_eq_u32 vcc, 2, v6
    s_nop 1
    v_cndmask_b32 v74, 0, v5, vcc
    v_cmp_eq_u32 vcc, 3, v6
    s_nop 1
    v_cndmask_b32 v75, 0, v5, vcc
    v_bfe_u32 v12, v1, 4, 1
    v_lshlrev_b32 v12, 7, v12
    v_lshl_add_u32 v12, v3, 4, v12
    v_lshrrev_b32 v10, 5, v1
    v_lshl_add_u32 v12, v10, 8, v12
    s_lshl_b32 s79, s3, 9
    v_add_u32 v12, s79, v12
    s_mov_b32 s79, 0x3f803f80
    v_mov_b32 v5, 0
    v_mov_b32 v6, 0
    s_waitcnt vmcnt(4)
    v_dot2_f32_bf16 v5, v40, s79, v5
    v_dot2_f32_bf16 v6, v40, v40, v6
    v_dot2_f32_bf16 v5, v41, s79, v5
    v_dot2_f32_bf16 v6, v41, v41, v6
    v_dot2_f32_bf16 v5, v42, s79, v5
    v_dot2_f32_bf16 v6, v42, v42, v6
    v_dot2_f32_bf16 v5, v43, s79, v5
    v_dot2_f32_bf16 v6, v43, v43, v6
    v_dot2_f32_bf16 v5, v44, s79, v5
    v_dot2_f32_bf16 v6, v44, v44, v6
    v_dot2_f32_bf16 v5, v45, s79, v5
    v_dot2_f32_bf16 v6, v45, v45, v6
    v_dot2_f32_bf16 v5, v46, s79, v5
    v_dot2_f32_bf16 v6, v46, v46, v6
    v_dot2_f32_bf16 v5, v47, s79, v5
    v_dot2_f32_bf16 v6, v47, v47, v6
    s_nop 1
    v_add_f32_dpp v5, v5, v5 row_ror:8 row_mask:0xf bank_mask:0xf
    v_add_f32_dpp v6, v6, v6 row_ror:8 row_mask:0xf bank_mask:0xf
    s_nop 0
    v_add_f32_dpp v5, v5, v5 row_ror:4 row_mask:0xf bank_mask:0xf
    v_add_f32_dpp v6, v6, v6 row_ror:4 row_mask:0xf bank_mask:0xf
    s_nop 0
    v_add_f32_dpp v5, v5, v5 row_ror:2 row_mask:0xf bank_mask:0xf
    v_add_f32_dpp v6, v6, v6 row_ror:2 row_mask:0xf bank_mask:0xf
    s_nop 0
    v_add_f32_dpp v5, v5, v5 row_ror:1 row_mask:0xf bank_mask:0xf
    v_add_f32_dpp v6, v6, v6 row_ror:1 row_mask:0xf bank_mask:0xf
    v_mov_b32 v7, v5
    s_nop 1
    v_permlane16_swap_b32 v5, v7
    v_add_f32 v5, v5, v7
    v_mov_b32 v7, v5
    s_nop 1
    v_permlane32_swap_b32 v5, v7
    v_add_f32 v5, v5, v7
    v_mov_b32 v8, v6
    s_nop 1
    v_permlane16_swap_b32 v6, v8
    v_add_f32 v6, v6, v8
    v_mov_b32 v8, v6
    s_nop 1
    v_permlane32_swap_b32 v6, v8
    v_add_f32 v6, v6, v8
    v_mul_f32 v5, 0x3ae38e39, v5
    v_mul_f32 v6, 0x3ae38e39, v6
    v_fma_f32 v6, -v5, v5, v6
    v_max_f32 v6, 0, v6
    v_cvt_pk_bf16_f32 v6, v6, v6
    v_and_b32 v6, 0xffff0000, v6
    v_cvt_pk_bf16_f32 v7, v5, v5
    v_and_b32 v7, 0xffff0000, v7
    v_add_f32 v6, 0x3727c5ac, v6
    v_cvt_pk_bf16_f32 v6, v6, v6
    v_and_b32 v6, 0xffff0000, v6
    v_sqrt_f32 v6, v6
    s_nop 0
    v_cvt_pk_bf16_f32 v8, v6, v6
    v_and_b32 v8, 0xffff0000, v8
    v_rcp_f32 v9, v8
    s_waitcnt vmcnt(2)
    v_lshlrev_b32 v48, 16, v48
    v_lshlrev_b32 v49, 16, v49
    v_sub_f32 v48, v48, v7
    v_sub_f32 v49, v49, v7
    v_cvt_pk_bf16_f32 v48, v48, v48
    v_cvt_pk_bf16_f32 v49, v49, v49
    v_and_b32 v48, 0xffff0000, v48
    v_and_b32 v49, 0xffff0000, v49
    v_mul_f32 v10, v48, v9
    v_mul_f32 v11, v49, v9
    v_fma_f32 v48, -v10, v8, v48
    v_fma_f32 v49, -v11, v8, v49
    v_fma_f32 v48, v48, v9, v10
    v_fma_f32 v49, v49, v9, v11
    v_cvt_pk_bf16_f32 v48, v48, v48
    v_and_b32 v64, v48, v72
    v_and_b32 v65, v48, v73
    v_and_b32 v66, v48, v74
    v_and_b32 v67, v48, v75
    v_cvt_pk_bf16_f32 v49, v49, v49
    v_and_b32 v68, v49, v72
    v_and_b32 v69, v49, v73
    v_and_b32 v70, v49, v74
    v_and_b32 v71, v49, v75
    s_waitcnt vmcnt(0)
    v_mfma_f32_16x16x32_bf16 v[24:27], v[56:59], v[64:67], 0
    v_mfma_f32_16x16x32_bf16 v[24:27], v[60:63], v[68:71], v[24:27]
    s_mov_b32 exec_lo, 0x00ff00ff
    s_mov_b32 exec_hi, 0xff00ff00
    s_nop 5
    ds_write_b128 v12, v[24:27] offset:5120
    v_mov_b32 v16, 1
    s_mov_b64 exec, 1
    ds_add_u32 v4, v16 offset:4
    s_mov_b64 exec, -1
Lnoq:
    s_waitcnt lgkmcnt(0)
    s_add_u32 s7, s7, 1
    s_cmp_lt_u32 s3, s83
    s_cbranch_scc1 Lqk
    s_cmp_lt_u32 s3, 8
    s_cbranch_scc1 Lpv
    s_cmp_eq_u32 s3, 8
    s_cbranch_scc1 Lattn_done
    s_cmp_eq_u32 s3, 12
    s_cbranch_scc1 Lw12
    s_cmp_eq_u32 s3, 14
    s_cbranch_scc1 Lfb
    s_cmp_ge_u32 s3, 10
    s_cbranch_scc1 Lqg
    v_lshlrev_b32 v5, 4, v1
    v_and_b32 v6, 8, v1
    v_lshl_add_u32 v6, v6, 2, v3
    v_lshrrev_b32 v7, 4, v1
    v_lshl_add_u32 v6, v7, 3, v6
    v_lshlrev_b32 v6, 3, v6
    s_lshl_b32 s79, s2, 9
    s_add_u32 s79, s79, 4096
    s_add_u32 s80, s79, 1048576
Lw_1:
    ds_read_b32 v16, v4 offset:4
    s_waitcnt lgkmcnt(0)
    v_readfirstlane_b32 s78, v16
    s_cmp_ge_u32 s78, 9
    s_cbranch_scc1 Lwk_2
    s_sub_u32 s0, s0, 1
    s_cbranch_scc0 Lw_1
    s_endpgm
Lwk_2:
    ds_read_b128 v[56:59], v5 offset:5120
    ds_read_b128 v[60:63], v5 offset:6144
    ds_read_b128 v[64:67], v5 offset:7168
    ds_read_b128 v[68:71], v5 offset:8192
    ds_read_b128 v[72:75], v5 offset:9216
    s_waitcnt lgkmcnt(0)
    v_add_f32 v56, v56, v60
    v_add_f32 v57, v57, v61
    v_add_f32 v58, v58, v62
    v_add_f32 v59, v59, v63
    v_add_f32 v56, v56, v64
    v_add_f32 v57, v57, v65
    v_add_f32 v58, v58, v66
    v_add_f32 v59, v59, v67
    v_add_f32 v56, v56, v68
    v_add_f32 v57, v57, v69
    v_add_f32 v58, v58, v70
    v_add_f32 v59, v59, v71
    v_add_f32 v56, v56, v72
    v_add_f32 v57, v57, v73
    v_add_f32 v58, v58, v74
    v_add_f32 v59, v59, v75
    v_permlane16_swap_b32 v56, v57
    s_nop 0
    v_permlane16_swap_b32 v58, v59
    v_add_f32 v56, v56, v57
    v_add_f32 v58, v58, v59
    s_nop 1
    v_permlane32_swap_b32 v56, v58
    v_add_f32 v56, v56, v58
    v_mov_b32 v57, s7
    buffer_store_dwordx2 v[56:57], v6, s[48:51], s80 offen
    ds_write_b64 v6, v[56:57] offset:10240
    v_mov_b32 v16, 1
    s_mov_b64 exec, 1
    ds_add_u32 v4, v16 offset:4
    s_mov_b64 exec, -1
    s_branch Lspub
Lqg:
    s_lshl_b32 s79, s4, 13
    s_lshl_b32 s80, s3, 10
    s_add_u32 s79, s79, s80
    s_add_u32 s79, s79, 1042432
    s_sub_u32 s79, s79, 1048576
    v_lshl_add_u32 v8, v1, 4, s79
    v_add_u32 v9, 4096, v8
    s_sub_u32 s80, s3, 10
    s_lshl_b32 s80, s80, 8
    v_lshl_add_u32 v10, v1, 2, s80
Lw_3:
    ds_read_b32 v16, v4 offset:4
    s_waitcnt lgkmcnt(0)
    v_readfirstlane_b32 s78, v16
    s_cmp_ge_u32 s78, 10
    s_cbranch_scc1 Lwk_4
    s_sleep 1
    s_sub_u32 s0, s0, 1
    s_cbranch_scc0 Lw_3
    s_endpgm
Lwk_4:
    s_cmp_ge_u32 s85, 32
    s_cbranch_scc1 Lpg_5
Lw_6:
    ds_read_b32 v16, v4 offset:0
    s_waitcnt lgkmcnt(0)
    v_readfirstlane_b32 s85, v16
    s_cmp_ge_u32 s85, 32
    s_cbranch_scc1 Lwk_7
    s_sleep 1
    s_sub_u32 s0, s0, 1
    s_cbranch_scc0 Lw_6
    s_endpgm
Lwk_7:
Lpg_5:
    s_mov_b64 s[88:89], -1
    s_mov_b64 s[90:91], -1
    s_mov_b64 s[92:93], -1
    s_mov_b64 s[94:95], -1
    s_mov_b32 s1, 1048576
    s_mov_b32 s81, 0x800000
Lqrt_8:
    s_mov_b64 exec, s[88:89]
    s_cbranch_execz Lsk_10
    buffer_load_dwordx4 v[40:43], v8, s[48:51], s1 offen offset:0 sc1
Lsk_10:
    s_mov_b64 exec, s[90:91]
    s_cbranch_execz Lsk_11
    buffer_load_dwordx4 v[44:47], v8, s[48:51], s1 offen offset:2048 sc1
Lsk_11:
    s_mov_b64 exec, s[92:93]
    s_cbranch_execz Lsk_12
    buffer_load_dwordx4 v[48:51], v9, s[48:51], s1 offen offset:0 sc1
Lsk_12:
    s_mov_b64 exec, s[94:95]
    s_cbranch_execz Lsk_13
    buffer_load_dwordx4 v[52:55], v9, s[48:51], s1 offen offset:2048 sc1
Lsk_13:
    s_waitcnt vmcnt(0)
    s_mov_b64 exec, s[88:89]
    v_bitop3_b32 v16, v41, v43, s7 bitop3:0x7e
    v_cmp_ne_u32 s[88:89], 0, v16
    s_mov_b64 exec, s[90:91]
    v_bitop3_b32 v16, v45, v47, s7 bitop3:0x7e
    v_cmp_ne_u32 s[90:91], 0, v16
    s_mov_b64 exec, s[92:93]
    v_bitop3_b32 v16, v49, v51, s7 bitop3:0x7e
    v_cmp_ne_u32 s[92:93], 0, v16
    s_mov_b64 exec, s[94:95]
    v_bitop3_b32 v16, v53, v55, s7 bitop3:0x7e
    v_cmp_ne_u32 s[94:95], 0, v16
    s_mov_b64 exec, -1
    s_or_b64 vcc, s[88:89], s[90:91]
    s_or_b64 vcc, vcc, s[92:93]
    s_or_b64 vcc, vcc, s[94:95]
    s_cbranch_scc0 Lqok_9
    s_cmp_lt_u32 s81, 0x7fffc1
    s_cselect_b32 s78, 1048576, 0
    s_xor_b32 s1, s1, s78
    s_sub_u32 s81, s81, 1
    s_cbranch_scc0 Lqrt_8
Lqok_9:
    v_add_f32 v40, v40, v44
    v_add_f32 v42, v42, v46
    v_add_f32 v48, v48, v52
    v_add_f32 v50, v50, v54
    v_add_f32 v40, v40, v48
    v_add_f32 v42, v42, v50
    v_cvt_pk_bf16_f32 v40, v40, v42
    ds_write_b32 v10, v40 offset:1152
    v_mov_b32 v16, 1
    s_mov_b64 exec, 1
    ds_add_u32 v4, v16 offset:8
    s_mov_b64 exec, -1
    s_branch Lattn_done
Lfb:
    v_lshlrev_b32 v13, 1, v1
    buffer_load_ushort v28, v13, s[56:59], 0 offen offset:0
    buffer_load_ushort v29, v13, s[56:59], 0 offen offset:128
    buffer_load_ushort v30, v13, s[56:59], 0 offen offset:256
    buffer_load_ushort v31, v13, s[56:59], 0 offen offset:384
    buffer_load_ushort v32, v13, s[56:59], 0 offen offset:512
    buffer_load_ushort v33, v13, s[56:59], 0 offen offset:640
    buffer_load_ushort v34, v13, s[56:59], 0 offen offset:768
    buffer_load_ushort v35, v13, s[56:59], 0 offen offset:896
    buffer_load_ushort v21, v13, s[56:59], 0 offen offset:1024
    v_lshlrev_b32 v13, 1, v1
    v_and_b32 v11, 15, v1
    v_lshlrev_b32 v11, 3, v11
    v_bfe_u32 v5, v1, 4, 1
    v_lshl_add_u32 v11, v5, 2, v11
    s_lshl_b32 s79, s82, 2
    v_lshrrev_b32 v12, 4, v1
    v_add_u32 v12, s79, v12
    v_lshlrev_b32 v12, 1, v12
    s_movk_i32 s81, 500
Lfbw:
    ds_read_b32 v16, v4 offset:40
    s_waitcnt lgkmcnt(0)
    v_readfirstlane_b32 s78, v16
    s_cmp_ge_u32 s78, 9
    s_cbranch_scc1 Lfbr
    s_cmp_lg_u32 s78, 0
    s_cbranch_scc1 Lfbn
    s_sleep 1
Lfbn:
    s_sub_u32 s81, s81, 1
    s_cbranch_scc0 Lfbw
    s_branch Lfbgo
Lfbr:
    s_cmp_lg_u32 s84, 0
    s_cbranch_scc1 Lfbgo
Lfbf:
    s_barrier
    s_barrier
    s_branch LFc
Lfbgo:
    v_lshlrev_b32 v5, 3, v1
    v_lshlrev_b32 v6, 4, v1
Lw_14:
    ds_read_b32 v16, v4 offset:4
    s_waitcnt lgkmcnt(0)
    v_readfirstlane_b32 s78, v16
    s_cmp_ge_u32 s78, 10
    s_cbranch_scc1 Lwk_15
    s_sleep 1
    s_sub_u32 s0, s0, 1
    s_cbranch_scc0 Lw_14
    s_endpgm
Lwk_15:
    ds_read_b64 v[40:41], v5 offset:10240
    s_lshl_b32 s79, s2, 9
    s_add_u32 s79, s79, 4096
    s_waitcnt lgkmcnt(0)
    buffer_store_dwordx2 v[40:41], v5, s[48:51], s79 offen sc1
Lw_16:
    ds_read_b32 v16, v4 offset:32
    s_waitcnt lgkmcnt(0)
    v_readfirstlane_b32 s78, v16
    s_cmp_ge_u32 s78, 1
    s_cbranch_scc1 Lwk_17
    s_sleep 1
    s_sub_u32 s0, s0, 1
    s_cbranch_scc0 Lw_16
    s_endpgm
Lwk_17:
    ds_read_b128 v[44:47], v6 offset:10752
    s_lshl_b32 s79, s6, 7
    s_add_u32 s79, s79, 196608
    s_waitcnt lgkmcnt(0)
    s_mov_b64 exec, 3
    buffer_store_dwordx4 v[44:47], v6, s[48:51], s79 offen sc1
    s_mov_b64 exec, -1
Lw_18:
    ds_read_b32 v16, v4 offset:24
    s_waitcnt lgkmcnt(0)
    v_readfirstlane_b32 s78, v16
    s_cmp_ge_u32 s78, 8
    s_cbranch_scc1 Lwk_19
    s_sleep 1
    s_sub_u32 s0, s0, 1
    s_cbranch_scc0 Lw_18
    s_endpgm
Lwk_19:
    ds_read_b128 v[48:51], v6 offset:11264
    s_lshl_b32 s79, s6, 10
    s_add_u32 s79, s79, 262144
    s_waitcnt lgkmcnt(0)
    buffer_store_dwordx4 v[48:51], v6, s[48:51], s79 offen sc1
    s_cmp_eq_u32 s84, 0
    s_cbranch_scc1 Lfbf
    s_endpgm
Lspub:
    v_and_b32 v9, 8, v1
    v_lshlrev_b32 v9, 3, v9
    v_lshlrev_b32 v8, 1, v1
    s_lshl_b32 s79, s6, 7
    s_add_u32 s79, s79, 196608
    s_add_u32 s80, s79, 1048576
Lw_20:
    ds_read_b32 v16, v4 offset:16
    s_waitcnt lgkmcnt(0)
    v_readfirstlane_b32 s78, v16
    s_cmp_ge_u32 s78, s83
    s_cbranch_scc1 Lwk_21
    s_sleep 1
    s_sub_u32 s0, s0, 1
    s_cbranch_scc0 Lw_20
    s_endpgm
Lwk_21:
    ds_read_b128 v[40:43], v9 offset:768
    ds_read_b128 v[44:47], v9 offset:784
    ds_read_b128 v[48:51], v9 offset:800
    ds_read_b128 v[56:59], v9 offset:896
    ds_read_b128 v[60:63], v9 offset:912
    ds_read_b128 v[64:67], v9 offset:928
    s_waitcnt lgkmcnt(0)
    v_max3_f32 v40, v40, v41, v42
    v_max3_f32 v43, v43, v44, v45
    v_max3_f32 v46, v46, v47, v48
    v_max3_f32 v40, v40, v43, v46
    v_add_f32 v56, v56, v57
    v_add_f32 v56, v56, v58
    v_add_f32 v56, v56, v59
    v_add_f32 v56, v56, v60
    v_add_f32 v56, v56, v61
    v_add_f32 v56, v56, v62
    v_add_f32 v56, v56, v63
    v_add_f32 v56, v56, v64
    v_mov_b32 v42, v56
    v_mov_b32 v41, s7
    v_mov_b32 v43, s7
    s_mov_b64 exec, 0x101
    buffer_store_dwordx4 v[40:43], v8, s[48:51], s80 offen
    ds_write_b128 v8, v[40:43] offset:10752
    v_mov_b32 v16, 1
    s_mov_b64 exec, 1
    ds_add_u32 v4, v16 offset:32
    s_mov_b64 exec, -1
    s_branch Lattn_done
Lqk:
    v_bfe_u32 v5, v1, 3, 1
    v_lshlrev_b32 v5, 8, v5
    v_lshrrev_b32 v6, 4, v1
    v_lshl_add_u32 v5, v6, 6, v5
    v_and_b32 v7, 3, v1
    v_lshl_add_u32 v5, v7, 4, v5
    v_bfe_i32 v14, v1, 2, 1
    s_lshl_b32 s79, s3, 5
    v_and_b32 v12, 4, v1
    v_add3_u32 v13, v6, v12, s79
    v_lshl_add_u32 v13, v7, 3, v13
    v_and_b32 v9, 8, v1
    v_mul_u32_u24 v10, 72, v9
    v_lshl_add_u32 v10, v13, 1, v10
    v_lshlrev_b32 v9, 3, v9
    s_lshl_b32 s79, s3, 2
    v_lshl_add_u32 v11, v1, 3, s79
    s_lshl_b32 s80, s3, 13
    s_add_u32 s80, s80, 12288
    v_lshl_add_u32 v15, v1, 4, s80
    s_lshl_b32 s80, s3, 3
    s_add_u32 s80, s80, 8
    s_cmp_ge_u32 s85, s80
    s_cbranch_scc1 Lpg_22
Lw_23:
    ds_read_b32 v16, v4 offset:0
    s_waitcnt lgkmcnt(0)
    v_readfirstlane_b32 s85, v16
    s_cmp_ge_u32 s85, s80
    s_cbranch_scc1 Lwk_24
    s_sleep 1
    s_sub_u32 s0, s0, 1
    s_cbranch_scc0 Lw_23
    s_endpgm
Lwk_24:
Lpg_22:
    ds_read_b128 v[56:59], v15 offset:0
    ds_read_b128 v[60:63], v15 offset:1024
    ds_read_b128 v[64:67], v15 offset:2048
    ds_read_b128 v[68:71], v15 offset:3072
    ds_read_b128 v[72:75], v15 offset:4096
    ds_read_b128 v[76:79], v15 offset:5120
    ds_read_b128 v[80:83], v15 offset:6144
    ds_read_b128 v[84:87], v15 offset:7168
    v_mov_b32 v16, 1
    s_mov_b64 exec, 1
    ds_add_u32 v4, v16 offset:20
    s_mov_b64 exec, -1
Lw_25:
    ds_read_b32 v16, v4 offset:8
    s_waitcnt lgkmcnt(0)
    v_readfirstlane_b32 s78, v16
    s_cmp_ge_u32 s78, 2
    s_cbranch_scc1 Lwk_26
    s_sleep 1
    s_sub_u32 s0, s0, 1
    s_cbranch_scc0 Lw_25
    s_endpgm
Lwk_26:
    ds_read_b128 v[40:43], v5 offset:1152
    s_waitcnt lgkmcnt(0)
    v_bfi_b32 v44, v14, 0, v40
    v_and_b32 v48, v14, v40
    v_bfi_b32 v45, v14, 0, v41
    v_and_b32 v49, v14, v41
    v_bfi_b32 v46, v14, 0, v42
    v_and_b32 v50, v14, v42
    v_bfi_b32 v47, v14, 0, v43
    v_and_b32 v51, v14, v43
    s_nop 0
    v_mfma_f32_16x16x32_bf16 v[24:27], v[56:59], v[44:47], 0
    v_mfma_f32_16x16x32_bf16 v[24:27], v[60:63], v[48:51], v[24:27]
    v_mfma_f32_16x16x32_bf16 v[28:31], v[64:67], v[44:47], 0
    v_mfma_f32_16x16x32_bf16 v[28:31], v[68:71], v[48:51], v[28:31]
    v_mfma_f32_16x16x32_bf16 v[32:35], v[72:75], v[44:47], 0
    v_mfma_f32_16x16x32_bf16 v[32:35], v[76:79], v[48:51], v[32:35]
    v_mfma_f32_16x16x32_bf16 v[36:39], v[80:83], v[44:47], 0
    v_mfma_f32_16x16x32_bf16 v[36:39], v[84:87], v[48:51], v[36:39]
    s_nop 1
    v_cndmask_b32 v5, v24, v25, s[72:73]
    v_cndmask_b32 v5, v5, v26, s[74:75]
    v_cndmask_b32 v5, v5, v27, s[76:77]
    v_cndmask_b32 v6, v28, v29, s[72:73]
    v_cndmask_b32 v6, v6, v30, s[74:75]
    v_cndmask_b32 v6, v6, v31, s[76:77]
    v_cndmask_b32 v7, v32, v33, s[72:73]
    v_cndmask_b32 v7, v7, v34, s[74:75]
    v_cndmask_b32 v7, v7, v35, s[76:77]
    v_cndmask_b32 v8, v36, v37, s[72:73]
    v_cndmask_b32 v8, v8, v38, s[74:75]
    v_cndmask_b32 v8, v8, v39, s[76:77]
    v_add_f32_dpp v5, v5, v5 quad_perm:[1,0,3,2] row_mask:0xf bank_mask:0xf
    v_add_f32_dpp v6, v6, v6 quad_perm:[1,0,3,2] row_mask:0xf bank_mask:0xf
    v_add_f32_dpp v7, v7, v7 quad_perm:[1,0,3,2] row_mask:0xf bank_mask:0xf
    v_add_f32_dpp v8, v8, v8 quad_perm:[1,0,3,2] row_mask:0xf bank_mask:0xf
    v_add_f32_dpp v5, v5, v5 quad_perm:[2,3,0,1] row_mask:0xf bank_mask:0xf
    v_add_f32_dpp v6, v6, v6 quad_perm:[2,3,0,1] row_mask:0xf bank_mask:0xf
    v_add_f32_dpp v7, v7, v7 quad_perm:[2,3,0,1] row_mask:0xf bank_mask:0xf
    v_add_f32_dpp v8, v8, v8 quad_perm:[2,3,0,1] row_mask:0xf bank_mask:0xf
    v_cndmask_b32 v5, v5, v6, s[72:73]
    v_cndmask_b32 v5, v5, v7, s[74:75]
    v_cndmask_b32 v5, v5, v8, s[76:77]
    v_cvt_pk_bf16_f32 v5, v5, v5
    v_and_b32 v5, 0xffff0000, v5
    v_mul_f32 v5, 0x3db504f3, v5
    v_cvt_pk_bf16_f32 v5, v5, v5
    v_and_b32 v5, 0xffff0000, v5
    v_mov_b32 v6, v5
    s_nop 1
    v_max_f32_dpp v6, v6, v6 quad_perm:[1,0,3,2] row_mask:0xf bank_mask:0xf
    s_nop 1
    v_max_f32_dpp v6, v6, v6 quad_perm:[2,3,0,1] row_mask:0xf bank_mask:0xf
    s_nop 1
    v_max_f32_dpp v6, v6, v6 row_half_mirror row_mask:0xf bank_mask:0xf
    v_mov_b32 v8, v6
    s_nop 1
    v_permlane16_swap_b32 v6, v8
    v_max_f32 v6, v6, v8
    v_mov_b32 v8, v6
    s_nop 1
    v_permlane32_swap_b32 v6, v8
    v_max_f32 v6, v6, v8
    s_mov_b64 exec, 0x101
    ds_write_b32 v11, v6 offset:768
    v_mov_b32 v16, 1
    s_mov_b64 exec, 1
    ds_add_u32 v4, v16 offset:12
    s_mov_b64 exec, -1
Lw_27:
    ds_read_b32 v16, v4 offset:12
    s_waitcnt lgkmcnt(0)
    v_readfirstlane_b32 s78, v16
    s_cmp_ge_u32 s78, s83
    s_cbranch_scc1 Lwk_28
    s_sub_u32 s0, s0, 1
    s_cbranch_scc0 Lw_27
    s_endpgm
Lwk_28:
    ds_read_b128 v[40:43], v9 offset:768
    ds_read_b128 v[44:47], v9 offset:784
    ds_read_b128 v[48:51], v9 offset:800
    s_waitcnt lgkmcnt(0)
    v_max3_f32 v40, v40, v41, v42
    v_max3_f32 v43, v43, v44, v45
    v_max3_f32 v46, v46, v47, v48
    v_max3_f32 v40, v40, v43, v46
    v_sub_f32 v5, v5, v40
    v_mul_f32 v5, 0x3fb8aa3b, v5
    v_exp_f32 v5, v5
    s_nop 0
    v_cvt_pk_bf16_f32 v6, v5, v5
    ds_write_b16 v10, v6 offset:1664
    v_add_f32_dpp v5, v5, v5 quad_perm:[1,0,3,2] row_mask:0xf bank_mask:0xf
    s_nop 1
    v_add_f32_dpp v5, v5, v5 quad_perm:[2,3,0,1] row_mask:0xf bank_mask:0xf
    s_nop 1
    v_add_f32_dpp v5, v5, v5 row_half_mirror row_mask:0xf bank_mask:0xf
    v_mov_b32 v6, v5
    s_nop 1
    v_permlane16_swap_b32 v5, v6
    v_add_f32 v5, v5, v6
    v_mov_b32 v6, v5
    s_nop 1
    v_permlane32_swap_b32 v5, v6
    v_add_f32 v5, v5, v6
    s_mov_b64 exec, 0x101
    ds_write_b32 v11, v5 offset:896
    v_mov_b32 v16, 1
    s_mov_b64 exec, 1
    ds_add_u32 v4, v16 offset:16
    s_mov_b64 exec, -1
    s_cmp_eq_u32 s3, 8
    s_cbranch_scc1 Lattn_done
Lpv:
    v_and_b32 v5, 1, v1
    v_lshlrev_b32 v6, 9, v5
    v_lshrrev_b32 v7, 4, v1
    v_lshl_add_u32 v6, v7, 4, v6
    v_lshl_add_u32 v10, v5, 6, v6
    v_bfe_u32 v8, v1, 2, 2
    v_and_b32 v9, 1, v7
    v_lshl_add_u32 v9, v9, 2, v8
    v_xor_b32 v9, s3, v9
    v_lshl_add_u32 v8, v7, 3, v8
    v_lshlrev_b32 v8, 8, v8
    v_lshl_add_u32 v8, v9, 5, v8
    v_and_b32 v9, 3, v1
    v_lshl_add_u32 v8, v9, 3, v8
    v_add_u32 v13, 86016, v8
    v_add_u32 v15, 151552, v8
    v_mov_b32 v12, v6
    s_lshl_b32 s79, s6, 10
    s_lshl_b32 s80, s3, 6
    v_add_u32 v14, s80, v12
    s_add_u32 s79, s79, s80
    s_add_u32 s79, s79, 262144
    s_add_u32 s80, s79, 1048576
    v_mov_b32 v41, s7
    v_mov_b32 v43, s7
Lw_29:
    ds_read_b32 v16, v4 offset:16
    s_waitcnt lgkmcnt(0)
    v_readfirstlane_b32 s78, v16
    s_cmp_ge_u32 s78, s83
    s_cbranch_scc1 Lwk_30
    s_sleep 1
    s_sub_u32 s0, s0, 1
    s_cbranch_scc0 Lw_29
    s_endpgm
Lwk_30:
    ds_read_b128 v[56:59], v10 offset:1664
    ds_read_b128 v[60:63], v10 offset:1728
    ds_read_b128 v[64:67], v10 offset:1792
    ds_read_b128 v[68:71], v10 offset:1856
    ds_read_b128 v[72:75], v10 offset:1920
    ds_read_b128 v[76:79], v10 offset:1984
    ds_read_b128 v[80:83], v10 offset:2048
    ds_read_b128 v[84:87], v10 offset:2112
    ds_read_b128 v[88:91], v10 offset:2176
    s_cmp_ge_u32 s85, 80
    s_cbranch_scc1 Lpg_31
Lw_32:
    ds_read_b32 v16, v4 offset:0
    s_waitcnt lgkmcnt(0)
    v_readfirstlane_b32 s85, v16
    s_cmp_ge_u32 s85, 80
    s_cbranch_scc1 Lwk_33
    s_sleep 1
    s_sub_u32 s0, s0, 1
    s_cbranch_scc0 Lw_32
    s_endpgm
Lwk_33:
Lpg_31:
    ds_read_b64_tr_b16 v[92:93], v13 offset:0
    ds_read_b64_tr_b16 v[94:95], v13 offset:1024
    s_cmp_ge_u32 s85, 88
    s_cbranch_scc1 Lpg_34
Lw_35:
    ds_read_b32 v16, v4 offset:0
    s_waitcnt lgkmcnt(0)
    v_readfirstlane_b32 s85, v16
    s_cmp_ge_u32 s85, 88
    s_cbranch_scc1 Lwk_36
    s_sleep 1
    s_sub_u32 s0, s0, 1
    s_cbranch_scc0 Lw_35
    s_endpgm
Lwk_36:
Lpg_34:
    ds_read_b64_tr_b16 v[96:97], v13 offset:8192
    ds_read_b64_tr_b16 v[98:99], v13 offset:9216
    s_waitcnt lgkmcnt(2)
    v_mfma_f32_16x16x32_bf16 v[24:27], v[92:95], v[56:59], 0
    s_cmp_ge_u32 s85, 96
    s_cbranch_scc1 Lpg_37
Lw_38:
    ds_read_b32 v16, v4 offset:0
    s_waitcnt lgkmcnt(0)
    v_readfirstlane_b32 s85, v16
    s_cmp_ge_u32 s85, 96
    s_cbranch_scc1 Lwk_39
    s_sleep 1
    s_sub_u32 s0, s0, 1
    s_cbranch_scc0 Lw_38
    s_endpgm
Lwk_39:
Lpg_37:
    ds_read_b64_tr_b16 v[100:101], v13 offset:16384
    ds_read_b64_tr_b16 v[102:103], v13 offset:17408
    s_waitcnt lgkmcnt(2)
    v_mfma_f32_16x16x32_bf16 v[24:27], v[96:99], v[60:63], v[24:27]
    s_cmp_ge_u32 s85, 104
    s_cbranch_scc1 Lpg_40
Lw_41:
    ds_read_b32 v16, v4 offset:0
    s_waitcnt lgkmcnt(0)
    v_readfirstlane_b32 s85, v16
    s_cmp_ge_u32 s85, 104
    s_cbranch_scc1 Lwk_42
    s_sleep 1
    s_sub_u32 s0, s0, 1
    s_cbranch_scc0 Lw_41
    s_endpgm
Lwk_42:
Lpg_40:
    ds_read_b64_tr_b16 v[104:105], v13 offset:24576
    ds_read_b64_tr_b16 v[106:107], v13 offset:25600
    s_waitcnt lgkmcnt(2)
    v_mfma_f32_16x16x32_bf16 v[24:27], v[100:103], v[64:67], v[24:27]
    s_cmp_ge_u32 s85, 112
    s_cbranch_scc1 Lpg_43
Lw_44:
    ds_read_b32 v16, v4 offset:0
    s_waitcnt lgkmcnt(0)
    v_readfirstlane_b32 s85, v16
    s_cmp_ge_u32 s85, 112
    s_cbranch_scc1 Lwk_45
    s_sleep 1
    s_sub_u32 s0, s0, 1
    s_cbranch_scc0 Lw_44
    s_endpgm
Lwk_45:
Lpg_43:
    ds_read_b64_tr_b16 v[108:109], v13 offset:32768
    ds_read_b64_tr_b16 v[110:111], v13 offset:33792
    s_waitcnt lgkmcnt(2)
    v_mfma_f32_16x16x32_bf16 v[24:27], v[104:107], v[68:71], v[24:27]
    s_cmp_eq_u32 s83, 5
    s_cbranch_scc1 Lpvf5
    s_cmp_ge_u32 s85, 120
    s_cbranch_scc1 Lpg_46
Lw_47:
    ds_read_b32 v16, v4 offset:0
    s_waitcnt lgkmcnt(0)
    v_readfirstlane_b32 s85, v16
    s_cmp_ge_u32 s85, 120
    s_cbranch_scc1 Lwk_48
    s_sleep 1
    s_sub_u32 s0, s0, 1
    s_cbranch_scc0 Lw_47
    s_endpgm
Lwk_48:
Lpg_46:
    ds_read_b64_tr_b16 v[112:113], v13 offset:40960
    ds_read_b64_tr_b16 v[114:115], v13 offset:41984
    s_waitcnt lgkmcnt(2)
    v_mfma_f32_16x16x32_bf16 v[24:27], v[108:111], v[72:75], v[24:27]
    s_cmp_eq_u32 s83, 6
    s_cbranch_scc1 Lpvf6
    s_cmp_ge_u32 s85, 128
    s_cbranch_scc1 Lpg_49
Lw_50:
    ds_read_b32 v16, v4 offset:0
    s_waitcnt lgkmcnt(0)
    v_readfirstlane_b32 s85, v16
    s_cmp_ge_u32 s85, 128
    s_cbranch_scc1 Lwk_51
    s_sleep 1
    s_sub_u32 s0, s0, 1
    s_cbranch_scc0 Lw_50
    s_endpgm
Lwk_51:
Lpg_49:
    ds_read_b64_tr_b16 v[116:117], v13 offset:49152
    ds_read_b64_tr_b16 v[118:119], v13 offset:50176
    s_waitcnt lgkmcnt(2)
    v_mfma_f32_16x16x32_bf16 v[24:27], v[112:115], v[76:79], v[24:27]
    s_cmp_eq_u32 s83, 7
    s_cbranch_scc1 Lpvf7
    s_cmp_ge_u32 s85, 136
    s_cbranch_scc1 Lpg_52
Lw_53:
    ds_read_b32 v16, v4 offset:0
    s_waitcnt lgkmcnt(0)
    v_readfirstlane_b32 s85, v16
    s_cmp_ge_u32 s85, 136
    s_cbranch_scc1 Lwk_54
    s_sleep 1
    s_sub_u32 s0, s0, 1
    s_cbranch_scc0 Lw_53
    s_endpgm
Lwk_54:
Lpg_52:
    ds_read_b64_tr_b16 v[120:121], v13 offset:57344
    ds_read_b64_tr_b16 v[122:123], v13 offset:58368
    s_waitcnt lgkmcnt(2)
    v_mfma_f32_16x16x32_bf16 v[24:27], v[116:119], v[80:83], v[24:27]
    s_cmp_eq_u32 s83, 8
    s_cbranch_scc1 Lpvf8
    s_cmp_ge_u32 s85, 144
    s_cbranch_scc1 Lpg_55
Lw_56:
    ds_read_b32 v16, v4 offset:0
    s_waitcnt lgkmcnt(0)
    v_readfirstlane_b32 s85, v16
    s_cmp_ge_u32 s85, 144
    s_cbranch_scc1 Lwk_57
    s_sub_u32 s0, s0, 1
    s_cbranch_scc0 Lw_56
    s_endpgm
Lwk_57:
Lpg_55:
    ds_read_b64_tr_b16 v[124:125], v15 offset:0
    ds_read_b64_tr_b16 v[126:127], v15 offset:1024
    s_waitcnt lgkmcnt(2)
    v_mfma_f32_16x16x32_bf16 v[24:27], v[120:123], v[84:87], v[24:27]
    s_waitcnt lgkmcnt(0)
    v_mfma_f32_16x16x32_bf16 v[24:27], v[124:127], v[88:91], v[24:27]
    s_branch Lpvend
Lpvf8:
    s_waitcnt lgkmcnt(0)
    v_mfma_f32_16x16x32_bf16 v[24:27], v[120:123], v[84:87], v[24:27]
    s_branch Lpvend
Lpvf7:
    s_waitcnt lgkmcnt(0)
    v_mfma_f32_16x16x32_bf16 v[24:27], v[116:119], v[80:83], v[24:27]
    s_branch Lpvend
Lpvf6:
    s_waitcnt lgkmcnt(0)
    v_mfma_f32_16x16x32_bf16 v[24:27], v[112:115], v[76:79], v[24:27]
    s_branch Lpvend
Lpvf5:
    s_waitcnt lgkmcnt(0)
    v_mfma_f32_16x16x32_bf16 v[24:27], v[108:111], v[72:75], v[24:27]
Lpvend:
    s_mov_b32 exec_lo, 0x00030003
    s_mov_b32 exec_hi, 0x00030003
    s_nop 5
    v_cvt_pk_bf16_f32 v40, v24, v25
    v_cvt_pk_bf16_f32 v42, v26, v27
    buffer_store_dwordx4 v[40:43], v12, s[48:51], s80 offen
    ds_write_b128 v14, v[40:43] offset:11264
    v_mov_b32 v16, 1
    s_mov_b64 exec, 1
    ds_add_u32 v4, v16 offset:24
    s_mov_b64 exec, -1
    s_branch Lattn_done
Lw12:
    s_waitcnt vmcnt(0)
Lattn_done:
    s_cmp_eq_u32 s84, 0
    s_cbranch_scc1 LF
    s_cmp_eq_u32 s84, 1
    s_cbranch_scc1 Lfin
    s_cmp_eq_u32 s3, 12
    s_cbranch_scc1 LWr
    s_cmp_ge_u32 s3, 4
    s_cbranch_scc1 LWg
    v_lshrrev_b32 v7, 4, v1
    v_bfe_u32 v8, v1, 2, 2
    v_lshlrev_b32 v8, 7, v8
    v_lshl_add_u32 v8, v7, 10, v8
    v_and_b32 v9, 3, v1
    v_lshl_add_u32 v8, v9, 3, v8
    s_lshl_b32 s79, s3, 5
    v_add_u32 v8, s79, v8
    v_add_u32 v9, 12288, v8
    s_cmp_ge_u32 s85, 152
    s_cbranch_scc1 Lpg_58
Lw_59:
    ds_read_b32 v16, v4 offset:0
    s_waitcnt lgkmcnt(0)
    v_readfirstlane_b32 s85, v16
    s_cmp_ge_u32 s85, 152
    s_cbranch_scc1 Lwk_60
    s_sleep 1
    s_sub_u32 s0, s0, 1
    s_cbranch_scc0 Lw_59
    s_endpgm
Lwk_60:
Lpg_58:
    ds_read_b64_tr_b16 v[56:57], v9 offset:0
    ds_read_b64_tr_b16 v[58:59], v9 offset:512
    ds_read_b64_tr_b16 v[60:61], v9 offset:4096
    ds_read_b64_tr_b16 v[62:63], v9 offset:4608
    s_cmp_ge_u32 s85, 160
    s_cbranch_scc1 Lpg_61
Lw_62:
    ds_read_b32 v16, v4 offset:0
    s_waitcnt lgkmcnt(0)
    v_readfirstlane_b32 s85, v16
    s_cmp_ge_u32 s85, 160
    s_cbranch_scc1 Lwk_63
    s_sleep 1
    s_sub_u32 s0, s0, 1
    s_cbranch_scc0 Lw_62
    s_endpgm
Lwk_63:
Lpg_61:
    ds_read_b64_tr_b16 v[64:65], v9 offset:8192
    ds_read_b64_tr_b16 v[66:67], v9 offset:8704
    ds_read_b64_tr_b16 v[68:69], v9 offset:12288
    ds_read_b64_tr_b16 v[70:71], v9 offset:12800
    s_cmp_ge_u32 s85, 168
    s_cbranch_scc1 Lpg_64
Lw_65:
    ds_read_b32 v16, v4 offset:0
    s_waitcnt lgkmcnt(0)
    v_readfirstlane_b32 s85, v16
    s_cmp_ge_u32 s85, 168
    s_cbranch_scc1 Lwk_66
    s_sleep 1
    s_sub_u32 s0, s0, 1
    s_cbranch_scc0 Lw_65
    s_endpgm
Lwk_66:
Lpg_64:
    ds_read_b64_tr_b16 v[72:73], v9 offset:16384
    ds_read_b64_tr_b16 v[74:75], v9 offset:16896
    ds_read_b64_tr_b16 v[76:77], v9 offset:20480
    ds_read_b64_tr_b16 v[78:79], v9 offset:20992
    s_cmp_ge_u32 s85, 176
    s_cbranch_scc1 Lpg_67
Lw_68:
    ds_read_b32 v16, v4 offset:0
    s_waitcnt lgkmcnt(0)
    v_readfirstlane_b32 s85, v16
    s_cmp_ge_u32 s85, 176
    s_cbranch_scc1 Lwk_69
    s_sleep 1
    s_sub_u32 s0, s0, 1
    s_cbranch_scc0 Lw_68
    s_endpgm
Lwk_69:
Lpg_67:
    ds_read_b64_tr_b16 v[80:81], v9 offset:24576
    ds_read_b64_tr_b16 v[82:83], v9 offset:25088
    ds_read_b64_tr_b16 v[84:85], v9 offset:28672
    ds_read_b64_tr_b16 v[86:87], v9 offset:29184
    s_cmp_ge_u32 s85, 184
    s_cbranch_scc1 Lpg_70
Lw_71:
    ds_read_b32 v16, v4 offset:0
    s_waitcnt lgkmcnt(0)
    v_readfirstlane_b32 s85, v16
    s_cmp_ge_u32 s85, 184
    s_cbranch_scc1 Lwk_72
    s_sleep 1
    s_sub_u32 s0, s0, 1
    s_cbranch_scc0 Lw_71
    s_endpgm
Lwk_72:
Lpg_70:
    ds_read_b64_tr_b16 v[88:89], v9 offset:32768
    ds_read_b64_tr_b16 v[90:91], v9 offset:33280
    ds_read_b64_tr_b16 v[92:93], v9 offset:36864
    ds_read_b64_tr_b16 v[94:95], v9 offset:37376
    s_cmp_ge_u32 s85, 192
    s_cbranch_scc1 Lpg_73
Lw_74:
    ds_read_b32 v16, v4 offset:0
    s_waitcnt lgkmcnt(0)
    v_readfirstlane_b32 s85, v16
    s_cmp_ge_u32 s85, 192
    s_cbranch_scc1 Lwk_75
    s_sleep 1
    s_sub_u32 s0, s0, 1
    s_cbranch_scc0 Lw_74
    s_endpgm
Lwk_75:
Lpg_73:
    ds_read_b64_tr_b16 v[96:97], v9 offset:40960
    ds_read_b64_tr_b16 v[98:99], v9 offset:41472
    ds_read_b64_tr_b16 v[100:101], v9 offset:45056
    ds_read_b64_tr_b16 v[102:103], v9 offset:45568
    s_cmp_ge_u32 s85, 200
    s_cbranch_scc1 Lpg_76
Lw_77:
    ds_read_b32 v16, v4 offset:0
    s_waitcnt lgkmcnt(0)
    v_readfirstlane_b32 s85, v16
    s_cmp_ge_u32 s85, 200
    s_cbranch_scc1 Lwk_78
    s_sleep 1
    s_sub_u32 s0, s0, 1
    s_cbranch_scc0 Lw_77
    s_endpgm
Lwk_78:
Lpg_76:
    ds_read_b64_tr_b16 v[104:105], v9 offset:49152
    ds_read_b64_tr_b16 v[106:107], v9 offset:49664
    ds_read_b64_tr_b16 v[108:109], v9 offset:53248
    ds_read_b64_tr_b16 v[110:111], v9 offset:53760
    s_cmp_ge_u32 s85, 208
    s_cbranch_scc1 Lpg_79
Lw_80:
    ds_read_b32 v16, v4 offset:0
    s_waitcnt lgkmcnt(0)
    v_readfirstlane_b32 s85, v16
    s_cmp_ge_u32 s85, 208
    s_cbranch_scc1 Lwk_81
    s_sleep 1
    s_sub_u32 s0, s0, 1
    s_cbranch_scc0 Lw_80
    s_endpgm
Lwk_81:
Lpg_79:
    ds_read_b64_tr_b16 v[112:113], v9 offset:57344
    ds_read_b64_tr_b16 v[114:115], v9 offset:57856
    ds_read_b64_tr_b16 v[116:117], v9 offset:61440
    ds_read_b64_tr_b16 v[118:119], v9 offset:61952
    v_lshlrev_b32 v6, 4, v7
    v_lshl_add_u32 v12, v3, 16, v6
    s_mul_i32 s79, s87, 4608
    s_lshl_b32 s80, s86, 9
    s_add_u32 s79, s79, s80
    s_lshl_b32 s80, s3, 7
    s_add_u32 s79, s79, s80
    s_add_u32 s79, s79, 1572864
    v_mov_b32 v29, s7
    v_mov_b32 v31, s7
    s_waitcnt lgkmcnt(0)
Lw_82:
    ds_read_b32 v16, v4 offset:28
    s_waitcnt lgkmcnt(0)
    v_readfirstlane_b32 s78, v16
    s_cmp_ge_u32 s78, 8
    s_cbranch_scc1 Lwk_83
    s_sub_u32 s0, s0, 1
    s_cbranch_scc0 Lw_82
    s_endpgm
Lwk_83:
    ds_read_b128 v[40:43], v6 offset:2816
    ds_read_b128 v[44:47], v6 offset:2880
    ds_read_b128 v[48:51], v6 offset:2944
    ds_read_b128 v[52:55], v6 offset:3008
    ds_read_b128 v[32:35], v6 offset:3072
    ds_read_b128 v[36:39], v6 offset:3136
    ds_read_b128 v[120:123], v6 offset:3200
    ds_read_b128 v[124:127], v6 offset:3264
    s_waitcnt lgkmcnt(7)
    v_mfma_f32_16x16x32_bf16 v[24:27], v[56:59], v[40:43], 0
    ds_read_b128 v[40:43], v6 offset:3328
    s_waitcnt lgkmcnt(7)
    v_mfma_f32_16x16x32_bf16 v[24:27], v[60:63], v[44:47], v[24:27]
    ds_read_b128 v[44:47], v6 offset:3392
    s_waitcnt lgkmcnt(7)
    v_mfma_f32_16x16x32_bf16 v[24:27], v[64:67], v[48:51], v[24:27]
    ds_read_b128 v[48:51], v6 offset:3456
    s_waitcnt lgkmcnt(7)
    v_mfma_f32_16x16x32_bf16 v[24:27], v[68:71], v[52:55], v[24:27]
    ds_read_b128 v[52:55], v6 offset:3520
    s_waitcnt lgkmcnt(7)
    v_mfma_f32_16x16x32_bf16 v[24:27], v[72:75], v[32:35], v[24:27]
    ds_read_b128 v[32:35], v6 offset:3584
    s_waitcnt lgkmcnt(7)
    v_mfma_f32_16x16x32_bf16 v[24:27], v[76:79], v[36:39], v[24:27]
    ds_read_b128 v[36:39], v6 offset:3648
    s_waitcnt lgkmcnt(7)
    v_mfma_f32_16x16x32_bf16 v[24:27], v[80:83], v[120:123], v[24:27]
    ds_read_b128 v[120:123], v6 offset:3712
    s_waitcnt lgkmcnt(7)
    v_mfma_f32_16x16x32_bf16 v[24:27], v[84:87], v[124:127], v[24:27]
    ds_read_b128 v[124:127], v6 offset:3776
    s_waitcnt lgkmcnt(7)
    v_mfma_f32_16x16x32_bf16 v[24:27], v[88:91], v[40:43], v[24:27]
    s_waitcnt lgkmcnt(6)
    v_mfma_f32_16x16x32_bf16 v[24:27], v[92:95], v[44:47], v[24:27]
    s_waitcnt lgkmcnt(5)
    v_mfma_f32_16x16x32_bf16 v[24:27], v[96:99], v[48:51], v[24:27]
    s_waitcnt lgkmcnt(4)
    v_mfma_f32_16x16x32_bf16 v[24:27], v[100:103], v[52:55], v[24:27]
    s_waitcnt lgkmcnt(3)
    v_mfma_f32_16x16x32_bf16 v[24:27], v[104:107], v[32:35], v[24:27]
    s_waitcnt lgkmcnt(2)
    v_mfma_f32_16x16x32_bf16 v[24:27], v[108:111], v[36:39], v[24:27]
    s_waitcnt lgkmcnt(1)
    v_mfma_f32_16x16x32_bf16 v[24:27], v[112:115], v[120:123], v[24:27]
    s_waitcnt lgkmcnt(0)
    v_mfma_f32_16x16x32_bf16 v[24:27], v[116:119], v[124:127], v[24:27]
    s_mov_b32 exec_lo, 0x00010001
    s_mov_b32 exec_hi, 0x00010001
    s_nop 5
    v_cvt_pk_bf16_f32 v28, v24, v25
    v_cvt_pk_bf16_f32 v30, v26, v27
    buffer_store_dwordx4 v[28:31], v12, s[48:51], s79 offen sc1
    v_mov_b32 v16, 1
    s_mov_b64 exec, 1
    ds_add_u32 v4, v16 offset:36
    s_mov_b64 exec, -1
    s_branch Lfin
LWg:
    s_sub_u32 s78, s3, 4
    s_lshr_b32 s79, s78, 2
    s_lshl_b32 s80, s87, 1
    s_add_u32 s80, s80, s79
    s_bfe_u32 s81, s78, 0x10001
    v_lshrrev_b32 v7, 4, v1
    v_lshl_add_u32 v8, v7, 2, v1
    v_and_b32 v8, 15, v8
    s_lshl_b32 s79, s80, 11
    s_lshl_b32 s83, s81, 4
    s_add_u32 s79, s79, s83
    s_add_u32 s79, s79, 196608
    v_lshl_add_u32 v12, v8, 7, s79
    s_lshl_b32 s80, s80, 14
    s_and_b32 s83, s78, 3
    s_lshl_b32 s79, s83, 8
    s_add_u32 s80, s80, s79
    s_add_u32 s80, s80, 262144
    v_and_b32 v8, 15, v1
    v_lshl_add_u32 v11, v8, 4, s80
    v_lshl_add_u32 v11, v7, 12, v11
    s_lshl_b32 s78, s78, 7
    v_and_b32 v8, 15, v1
    v_lshl_add_u32 v15, v8, 3, s78
    v_and_b32 v9, 1, v1
    v_lshlrev_b32 v9, 4, v9
    v_mov_b32 v10, 0xffff
    v_lshlrev_b32 v9, v9, v10
    v_bfe_i32 v10, v1, 1, 1
    v_bfi_b32 v13, v10, 0, v9
    v_and_b32 v14, v10, v9
    s_cmp_ge_u32 s85, 168
    s_cbranch_scc1 Lpg_84
Lw_85:
    ds_read_b32 v16, v4 offset:0
    s_waitcnt lgkmcnt(0)
    v_readfirstlane_b32 s85, v16
    s_cmp_ge_u32 s85, 168
    s_cbranch_scc1 Lwk_86
    s_sleep 1
    s_sub_u32 s0, s0, 1
    s_cbranch_scc0 Lw_85
    s_endpgm
Lwk_86:
Lpg_84:
    s_mov_b64 s[88:89], -1
    s_mov_b32 s1, 1048576
    s_mov_b32 s81, 0x800000
Lsrt_87:
    s_mov_b64 exec, s[88:89]
    s_cbranch_execz Lsk_89
    buffer_load_dwordx4 v[40:43], v12, s[48:51], s1 offen sc1
Lsk_89:
    s_waitcnt vmcnt(0)
    s_mov_b64 exec, s[88:89]
    v_bitop3_b32 v16, v41, v43, s7 bitop3:0x7e
    v_cmp_ne_u32 s[88:89], 0, v16
    s_mov_b64 exec, -1
    s_cmp_eq_u64 s[88:89], 0
    s_cbranch_scc1 Lsok_88
    s_cmp_lt_u32 s81, 0x7fffc1
    s_cselect_b32 s78, 1048576, 0
    s_xor_b32 s1, s1, s78
    s_sub_u32 s81, s81, 1
    s_cbranch_scc0 Lsrt_87
Lsok_88:
    v_mov_b32 v41, v40
    s_nop 1
    v_max_f32_dpp v41, v41, v41 row_ror:8 row_mask:0xf bank_mask:0xf
    s_nop 1
    v_max_f32_dpp v41, v41, v41 row_ror:4 row_mask:0xf bank_mask:0xf
    s_nop 1
    v_max_f32_dpp v41, v41, v41 row_ror:2 row_mask:0xf bank_mask:0xf
    s_nop 1
    v_max_f32_dpp v41, v41, v41 row_ror:1 row_mask:0xf bank_mask:0xf
    v_sub_f32 v40, v40, v41
    v_mul_f32 v40, 0x3fb8aa3b, v40
    v_exp_f32 v40, v40
    s_nop 0
    v_mul_f32 v42, v40, v42
    s_nop 1
    v_add_f32_dpp v42, v42, v42 row_ror:8 row_mask:0xf bank_mask:0xf
    s_nop 1
    v_add_f32_dpp v42, v42, v42 row_ror:4 row_mask:0xf bank_mask:0xf
    s_nop 1
    v_add_f32_dpp v42, v42, v42 row_ror:2 row_mask:0xf bank_mask:0xf
    s_nop 1
    v_add_f32_dpp v42, v42, v42 row_ror:1 row_mask:0xf bank_mask:0xf
    v_rcp_f32 v42, v42
    s_nop 0
    v_mul_f32 v40, v40, v42
    v_cvt_pk_bf16_f32 v41, v40, v40
    v_and_b32 v42, 0xffff0000, v41
    v_sub_f32 v40, v40, v42
    v_cvt_pk_bf16_f32 v42, v40, v40
    v_and_b32_dpp v56, v41, v13 row_newbcast:0 row_mask:0xf bank_mask:0xf
    v_and_b32_dpp v57, v41, v14 row_newbcast:0 row_mask:0xf bank_mask:0xf
    v_and_b32_dpp v64, v42, v13 row_newbcast:0 row_mask:0xf bank_mask:0xf
    v_and_b32_dpp v65, v42, v14 row_newbcast:0 row_mask:0xf bank_mask:0xf
    v_and_b32_dpp v58, v41, v13 row_newbcast:1 row_mask:0xf bank_mask:0xf
    v_and_b32_dpp v59, v41, v14 row_newbcast:1 row_mask:0xf bank_mask:0xf
    v_and_b32_dpp v66, v42, v13 row_newbcast:1 row_mask:0xf bank_mask:0xf
    v_and_b32_dpp v67, v42, v14 row_newbcast:1 row_mask:0xf bank_mask:0xf
    v_and_b32_dpp v60, v41, v13 row_newbcast:2 row_mask:0xf bank_mask:0xf
    v_and_b32_dpp v61, v41, v14 row_newbcast:2 row_mask:0xf bank_mask:0xf
    v_and_b32_dpp v68, v42, v13 row_newbcast:2 row_mask:0xf bank_mask:0xf
    v_and_b32_dpp v69, v42, v14 row_newbcast:2 row_mask:0xf bank_mask:0xf
    v_and_b32_dpp v62, v41, v13 row_newbcast:3 row_mask:0xf bank_mask:0xf
    v_and_b32_dpp v63, v41, v14 row_newbcast:3 row_mask:0xf bank_mask:0xf
    v_and_b32_dpp v70, v42, v13 row_newbcast:3 row_mask:0xf bank_mask:0xf
    v_and_b32_dpp v71, v42, v14 row_newbcast:3 row_mask:0xf bank_mask:0xf
    s_cmp_ge_u32 s85, 192
    s_cbranch_scc1 Lpg_90
Lw_91:
    ds_read_b32 v16, v4 offset:0
    s_waitcnt lgkmcnt(0)
    v_readfirstlane_b32 s85, v16
    s_cmp_ge_u32 s85, 192
    s_cbranch_scc1 Lwk_92
    s_sleep 1
    s_sub_u32 s0, s0, 1
    s_cbranch_scc0 Lw_91
    s_endpgm
Lwk_92:
Lpg_90:
    s_mov_b64 s[88:89], -1
    s_mov_b64 s[90:91], -1
    s_mov_b64 s[92:93], -1
    s_mov_b64 s[94:95], -1
    s_mov_b32 s1, 1048576
    s_mov_b32 s81, 0x800000
Lart_93:
    s_mov_b64 exec, s[88:89]
    s_cbranch_execz Lsk_95
    buffer_load_dwordx4 v[40:43], v11, s[48:51], s1 offen offset:0 sc1
Lsk_95:
    s_mov_b64 exec, s[90:91]
    s_cbranch_execz Lsk_96
    buffer_load_dwordx4 v[44:47], v11, s[48:51], s1 offen offset:1024 sc1
Lsk_96:
    s_mov_b64 exec, s[92:93]
    s_cbranch_execz Lsk_97
    buffer_load_dwordx4 v[48:51], v11, s[48:51], s1 offen offset:2048 sc1
Lsk_97:
    s_mov_b64 exec, s[94:95]
    s_cbranch_execz Lsk_98
    buffer_load_dwordx4 v[52:55], v11, s[48:51], s1 offen offset:3072 sc1
Lsk_98:
    s_waitcnt vmcnt(0)
    s_mov_b64 exec, s[88:89]
    v_bitop3_b32 v16, v41, v43, s7 bitop3:0x7e
    v_cmp_ne_u32 s[88:89], 0, v16
    s_mov_b64 exec, s[90:91]
    v_bitop3_b32 v16, v45, v47, s7 bitop3:0x7e
    v_cmp_ne_u32 s[90:91], 0, v16
    s_mov_b64 exec, s[92:93]
    v_bitop3_b32 v16, v49, v51, s7 bitop3:0x7e
    v_cmp_ne_u32 s[92:93], 0, v16
    s_mov_b64 exec, s[94:95]
    v_bitop3_b32 v16, v53, v55, s7 bitop3:0x7e
    v_cmp_ne_u32 s[94:95], 0, v16
    s_mov_b64 exec, -1
    s_or_b64 vcc, s[88:89], s[90:91]
    s_or_b64 vcc, vcc, s[92:93]
    s_or_b64 vcc, vcc, s[94:95]
    s_cbranch_scc0 Laok_94
    s_cmp_lt_u32 s81, 0x7fffc1
    s_cselect_b32 s78, 1048576, 0
    s_xor_b32 s1, s1, s78
    s_sub_u32 s81, s81, 1
    s_cbranch_scc0 Lart_93
Laok_94:
    v_mov_b32 v41, v42
    v_mov_b32 v42, v44
    v_mov_b32 v43, v46
    v_mov_b32 v49, v50
    v_mov_b32 v50, v52
    v_mov_b32 v51, v54
    v_mfma_f32_16x16x32_bf16 v[24:27], v[56:59], v[40:43], 0
    v_mfma_f32_16x16x32_bf16 v[24:27], v[64:67], v[40:43], v[24:27]
    v_mfma_f32_16x16x32_bf16 v[24:27], v[60:63], v[48:51], v[24:27]
    v_mfma_f32_16x16x32_bf16 v[24:27], v[68:71], v[48:51], v[24:27]
    s_mov_b64 exec, 0xffff
    s_nop 6
    v_cvt_pk_bf16_f32 v24, v24, v25
    v_cvt_pk_bf16_f32 v25, v26, v27
    ds_write_b64 v15, v[24:25] offset:2816
    v_mov_b32 v16, 1
    s_mov_b64 exec, 1
    ds_add_u32 v4, v16 offset:28
    s_mov_b64 exec, -1
    s_branch Lfin
LWr:
    v_and_b32 v8, 15, v1
    s_lshl_b32 s79, s86, 7
    v_lshl_add_u32 v12, v8, 3, s79
    buffer_load_dwordx2 v[64:65], v12, s[32:35], 0 offen
    v_lshrrev_b32 v7, 4, v1
    v_mul_u32_u24 v13, 4608, v7
    v_lshl_add_u32 v13, v8, 4, v13
    v_and_b32 v14, 12, v1
    v_lshl_add_u32 v13, v14, 4, v13
    s_lshl_b32 s78, s86, 9
    s_add_u32 s78, s78, 1572864
    v_add_u32 v13, s78, v13
    v_add_u32 v14, 18432, v13
    s_lshl_b32 s79, s87, 12
    s_mul_i32 s80, s86, 384
    s_add_u32 s79, s79, s80
    s_add_u32 s83, s79, 229376
    s_add_u32 s72, s83, 1048576
    v_lshlrev_b32 v12, 7, v1
    s_mov_b64 exec, 7
    buffer_load_dword v20, v12, s[48:51], s72 offen sc1
    s_mov_b64 exec, -1
    v_lshlrev_b32 v12, 4, v1
    v_mov_b32 v29, s7
    v_mov_b32 v31, s7
    s_mov_b32 s74, 0x3f803f80
    s_mov_b32 s76, 0x10000
    s_mov_b32 s77, 0
    v_and_b32 v9, 1, v1
    v_lshlrev_b32 v9, 4, v9
    v_mov_b32 v10, 0x3f80
    v_lshlrev_b32 v9, v9, v10
    v_bfe_i32 v10, v1, 1, 1
    v_bfi_b32 v56, v10, 0, v9
    v_and_b32 v57, v10, v9
    v_mov_b32 v58, v56
    v_mov_b32 v59, v57
    s_waitcnt vmcnt(0)
    v_lshlrev_b32 v66, 16, v64
    v_and_b32 v67, 0xffff0000, v64
    v_lshlrev_b32 v68, 16, v65
    v_and_b32 v69, 0xffff0000, v65
Lw_99:
    ds_read_b32 v16, v4 offset:36
    s_waitcnt lgkmcnt(0)
    v_readfirstlane_b32 s78, v16
    s_cmp_ge_u32 s78, 1
    s_cbranch_scc1 Lwk_100
    s_sleep 1
    s_sub_u32 s0, s0, 1
    s_cbranch_scc0 Lw_99
    s_endpgm
Lwk_100:
    s_mov_b64 s[88:89], -1
    s_mov_b64 s[90:91], -1
    s_mov_b32 s81, 0x800000
Lrrt_101:
    s_mov_b64 exec, s[88:89]
    s_cbranch_execz Lsk_103
    buffer_load_dwordx4 v[40:43], v13, s[48:51], 0 offen sc1
Lsk_103:
    s_mov_b64 exec, s[90:91]
    s_cbranch_execz Lsk_104
    buffer_load_dwordx4 v[44:47], v14, s[48:51], 0 offen sc1
Lsk_104:
    s_waitcnt vmcnt(0)
    s_mov_b64 exec, s[88:89]
    v_bitop3_b32 v16, v41, v43, s7 bitop3:0x7e
    v_cmp_ne_u32 s[88:89], 0, v16
    s_mov_b64 exec, s[90:91]
    v_bitop3_b32 v16, v45, v47, s7 bitop3:0x7e
    v_cmp_ne_u32 s[90:91], 0, v16
    s_mov_b64 exec, -1
    s_or_b64 vcc, s[88:89], s[90:91]
    s_cbranch_scc0 Lrok_102
    s_sub_u32 s81, s81, 1
    s_cbranch_scc0 Lrrt_101
Lrok_102:
    v_mov_b32 v41, v42
    v_mov_b32 v42, v44
    v_mov_b32 v43, v46
    s_nop 1
    v_mfma_f32_16x16x32_bf16 v[24:27], v[56:59], v[40:43], 0
    s_nop 7
    v_cvt_pk_bf16_f32 v24, v24, v25
    v_cvt_pk_bf16_f32 v26, v26, v27
    v_and_b32 v25, 0xffff0000, v24
    v_lshlrev_b32 v24, 16, v24
    v_and_b32 v27, 0xffff0000, v26
    v_lshlrev_b32 v26, 16, v26
    v_add_f32 v24, v24, v66
    v_add_f32 v25, v25, v67
    v_add_f32 v26, v26, v68
    v_add_f32 v27, v27, v69
    v_cvt_pk_bf16_f32 v28, v24, v25
    v_cvt_pk_bf16_f32 v30, v26, v27
    v_dot2_f32_bf16 v5, v28, s74, 0
    v_dot2_f32_bf16 v6, v28, v28, 0
    v_dot2_f32_bf16 v5, v30, s74, v5
    v_dot2_f32_bf16 v6, v30, v30, v6
    s_nop 1
    v_add_f32_dpp v5, v5, v5 row_ror:8 row_mask:0xf bank_mask:0xf
    v_add_f32_dpp v6, v6, v6 row_ror:8 row_mask:0xf bank_mask:0xf
    s_nop 0
    v_add_f32_dpp v5, v5, v5 row_ror:4 row_mask:0xf bank_mask:0xf
    v_add_f32_dpp v6, v6, v6 row_ror:4 row_mask:0xf bank_mask:0xf
    s_nop 0
    v_add_f32_dpp v5, v5, v5 row_ror:2 row_mask:0xf bank_mask:0xf
    v_add_f32_dpp v6, v6, v6 row_ror:2 row_mask:0xf bank_mask:0xf
    s_nop 0
    v_add_f32_dpp v5, v5, v5 row_ror:1 row_mask:0xf bank_mask:0xf
    v_add_f32_dpp v6, v6, v6 row_ror:1 row_mask:0xf bank_mask:0xf
    v_cndmask_b32 v28, v28, v5, s[76:77]
    v_cndmask_b32 v30, v30, v6, s[76:77]
    s_mov_b64 exec, 0x1ffff
    buffer_store_dwordx4 v[28:31], v12, s[48:51], s72 offen
    buffer_store_dwordx4 v[28:31], v12, s[48:51], s83 offen sc1
    v_mov_b32 v16, 9
    s_mov_b64 exec, 1
    ds_write_b32 v4, v16 offset:40
    s_mov_b64 exec, -1
    s_branch Lfin
LF:
    s_cmp_ge_u32 s3, 4
    s_cbranch_scc1 LFg
    v_lshrrev_b32 v7, 4, v1
    v_bfe_u32 v8, v1, 2, 2
    v_lshl_add_u32 v8, v7, 3, v8
    v_lshlrev_b32 v8, 6, v8
    v_and_b32 v9, 1, v7
    v_and_b32 v10, 2, v1
    v_or_b32 v9, v9, v10
    v_xor_b32 v9, s3, v9
    v_lshl_add_u32 v8, v9, 4, v8
    v_and_b32 v9, 1, v1
    v_lshl_add_u32 v8, v9, 3, v8
    v_mul_u32_u24 v10, 18432, v10
    v_add3_u32 v8, v8, v10, v4
    v_add_u32 v8, 12288, v8
    v_mul_u32_u24 v6, 1152, v9
    v_lshl_add_u32 v6, v7, 4, v6
    v_and_b32 v11, 15, v1
    v_lshlrev_b32 v11, 3, v11
    v_bfe_u32 v5, v1, 4, 1
    v_lshl_add_u32 v11, v5, 2, v11
    v_bfe_u32 v12, v1, 1, 2
    v_and_b32 v13, 1, v7
    v_lshl_add_u32 v12, v13, 2, v12
    s_lshl_b32 s79, s3, 3
    v_add_u32 v12, s79, v12
    v_lshlrev_b32 v12, 1, v12
    s_mov_b32 s72, 0x0c0c0c0c
    s_mov_b32 s73, 0x0c0c0c0c
    s_mov_b32 s74, 0x30303030
    s_mov_b32 s75, 0x30303030
    s_mov_b32 s76, 0xc0c0c0c0
    s_mov_b32 s77, 0xc0c0c0c0
    s_and_b32 s79, s82, 1
    s_lshl_b32 s80, s79, 6
    v_add_u32 v6, 2816, v6
    v_add_u32 v10, s80, v6
    v_subrev_u32 v6, s80, v6
    s_cmp_ge_u32 s85, 152
    s_cbranch_scc1 Lpg_105
Lw_106:
    ds_read_b32 v16, v4 offset:0
    s_waitcnt lgkmcnt(0)
    v_readfirstlane_b32 s85, v16
    s_cmp_ge_u32 s85, 152
    s_cbranch_scc1 Lwk_107
    s_sleep 1
    s_sub_u32 s0, s0, 1
    s_cbranch_scc0 Lw_106
    s_endpgm
Lwk_107:
Lpg_105:
    ds_read_b64_tr_b16 v[56:57], v8 offset:0
    ds_read_b64_tr_b16 v[58:59], v8 offset:256
    ds_read_b64_tr_b16 v[60:61], v8 offset:4096
    ds_read_b64_tr_b16 v[62:63], v8 offset:4352
    s_cmp_ge_u32 s85, 160
    s_cbranch_scc1 Lpg_108
Lw_109:
    ds_read_b32 v16, v4 offset:0
    s_waitcnt lgkmcnt(0)
    v_readfirstlane_b32 s85, v16
    s_cmp_ge_u32 s85, 160
    s_cbranch_scc1 Lwk_110
    s_sleep 1
    s_sub_u32 s0, s0, 1
    s_cbranch_scc0 Lw_109
    s_endpgm
Lwk_110:
Lpg_108:
    ds_read_b64_tr_b16 v[64:65], v8 offset:8192
    ds_read_b64_tr_b16 v[66:67], v8 offset:8448
    ds_read_b64_tr_b16 v[68:69], v8 offset:12288
    ds_read_b64_tr_b16 v[70:71], v8 offset:12544
    s_cmp_ge_u32 s85, 168
    s_cbranch_scc1 Lpg_111
Lw_112:
    ds_read_b32 v16, v4 offset:0
    s_waitcnt lgkmcnt(0)
    v_readfirstlane_b32 s85, v16
    s_cmp_ge_u32 s85, 168
    s_cbranch_scc1 Lwk_113
    s_sleep 1
    s_sub_u32 s0, s0, 1
    s_cbranch_scc0 Lw_112
    s_endpgm
Lwk_113:
Lpg_111:
    ds_read_b64_tr_b16 v[72:73], v8 offset:16384
    ds_read_b64_tr_b16 v[74:75], v8 offset:16640
    ds_read_b64_tr_b16 v[76:77], v8 offset:20480
    ds_read_b64_tr_b16 v[78:79], v8 offset:20736
    s_cmp_ge_u32 s85, 176
    s_cbranch_scc1 Lpg_114
Lw_115:
    ds_read_b32 v16, v4 offset:0
    s_waitcnt lgkmcnt(0)
    v_readfirstlane_b32 s85, v16
    s_cmp_ge_u32 s85, 176
    s_cbranch_scc1 Lwk_116
    s_sleep 1
    s_sub_u32 s0, s0, 1
    s_cbranch_scc0 Lw_115
    s_endpgm
Lwk_116:
Lpg_114:
    ds_read_b64_tr_b16 v[80:81], v8 offset:24576
    ds_read_b64_tr_b16 v[82:83], v8 offset:24832
    ds_read_b64_tr_b16 v[84:85], v8 offset:28672
    ds_read_b64_tr_b16 v[86:87], v8 offset:28928
    s_cmp_ge_u32 s85, 220
    s_cbranch_scc1 Lpg_117
Lw_118:
    ds_read_b32 v16, v4 offset:0
    s_waitcnt lgkmcnt(0)
    v_readfirstlane_b32 s85, v16
    s_cmp_ge_u32 s85, 220
    s_cbranch_scc1 Lwk_119
    s_sleep 1
    s_sub_u32 s0, s0, 1
    s_cbranch_scc0 Lw_118
    s_endpgm
Lwk_119:
Lpg_117:
    ds_read_b64_tr_b16 v[88:89], v8 offset:32768
    ds_read_b64_tr_b16 v[90:91], v8 offset:33024
    ds_read_b64_tr_b16 v[92:93], v8 offset:2048
    ds_read_b64_tr_b16 v[94:95], v8 offset:2304
    s_cmp_ge_u32 s85, 228
    s_cbranch_scc1 Lpg_120
Lw_121:
    ds_read_b32 v16, v4 offset:0
    s_waitcnt lgkmcnt(0)
    v_readfirstlane_b32 s85, v16
    s_cmp_ge_u32 s85, 228
    s_cbranch_scc1 Lwk_122
    s_sleep 1
    s_sub_u32 s0, s0, 1
    s_cbranch_scc0 Lw_121
    s_endpgm
Lwk_122:
Lpg_120:
    ds_read_b64_tr_b16 v[96:97], v8 offset:6144
    ds_read_b64_tr_b16 v[98:99], v8 offset:6400
    ds_read_b64_tr_b16 v[100:101], v8 offset:10240
    ds_read_b64_tr_b16 v[102:103], v8 offset:10496
    s_cmp_ge_u32 s85, 236
    s_cbranch_scc1 Lpg_123
Lw_124:
    ds_read_b32 v16, v4 offset:0
    s_waitcnt lgkmcnt(0)
    v_readfirstlane_b32 s85, v16
    s_cmp_ge_u32 s85, 236
    s_cbranch_scc1 Lwk_125
    s_sleep 1
    s_sub_u32 s0, s0, 1
    s_cbranch_scc0 Lw_124
    s_endpgm
Lwk_125:
Lpg_123:
    ds_read_b64_tr_b16 v[104:105], v8 offset:14336
    ds_read_b64_tr_b16 v[106:107], v8 offset:14592
    ds_read_b64_tr_b16 v[108:109], v8 offset:18432
    ds_read_b64_tr_b16 v[110:111], v8 offset:18688
    s_cmp_ge_u32 s85, 244
    s_cbranch_scc1 Lpg_126
Lw_127:
    ds_read_b32 v16, v4 offset:0
    s_waitcnt lgkmcnt(0)
    v_readfirstlane_b32 s85, v16
    s_cmp_ge_u32 s85, 244
    s_cbranch_scc1 Lwk_128
    s_sleep 1
    s_sub_u32 s0, s0, 1
    s_cbranch_scc0 Lw_127
    s_endpgm
Lwk_128:
Lpg_126:
    ds_read_b64_tr_b16 v[112:113], v8 offset:22528
    ds_read_b64_tr_b16 v[114:115], v8 offset:22784
    ds_read_b64_tr_b16 v[116:117], v8 offset:26624
    ds_read_b64_tr_b16 v[118:119], v8 offset:26880
    s_cmp_ge_u32 s85, 248
    s_cbranch_scc1 Lpg_129
Lw_130:
    ds_read_b32 v16, v4 offset:0
    s_waitcnt lgkmcnt(0)
    v_readfirstlane_b32 s85, v16
    s_cmp_ge_u32 s85, 248
    s_cbranch_scc1 Lwk_131
    s_sub_u32 s0, s0, 1
    s_cbranch_scc0 Lw_130
    s_endpgm
Lwk_131:
Lpg_129:
    ds_read_b64_tr_b16 v[120:121], v8 offset:30720
    ds_read_b64_tr_b16 v[122:123], v8 offset:30976
    s_cmp_ge_u32 s85, 252
    s_cbranch_scc1 Lpg_132
Lw_133:
    ds_read_b32 v16, v4 offset:0
    s_waitcnt lgkmcnt(0)
    v_readfirstlane_b32 s85, v16
    s_cmp_ge_u32 s85, 252
    s_cbranch_scc1 Lwk_134
    s_sub_u32 s0, s0, 1
    s_cbranch_scc0 Lw_133
    s_endpgm
Lwk_134:
Lpg_132:
    ds_read_b64_tr_b16 v[124:125], v8 offset:34816
    ds_read_b64_tr_b16 v[126:127], v8 offset:35072
    s_setprio 3
    s_waitcnt lgkmcnt(0)
    s_barrier
    ds_read_b32 v14, v11 offset:64
    ds_read_b128 v[40:43], v10 offset:0
    ds_read_b128 v[44:47], v10 offset:128
    ds_read_b128 v[48:51], v10 offset:256
    ds_read_b128 v[52:55], v10 offset:384
    ds_read_b128 v[28:31], v10 offset:512
    ds_read_b128 v[32:35], v10 offset:640
    ds_read_b128 v[36:39], v10 offset:768
    s_waitcnt lgkmcnt(6)
    v_mfma_f32_16x16x32_bf16 v[24:27], v[56:59], v[40:43], 0
    ds_read_b128 v[40:43], v10 offset:896
    v_add_f32_dpp v14, v14, v14 row_ror:8 row_mask:0xf bank_mask:0xf
    s_waitcnt lgkmcnt(6)
    v_mfma_f32_16x16x32_bf16 v[24:27], v[60:63], v[44:47], v[24:27]
    ds_read_b128 v[44:47], v10 offset:1024
    v_add_f32_dpp v14, v14, v14 row_ror:4 row_mask:0xf bank_mask:0xf
    s_waitcnt lgkmcnt(6)
    v_mfma_f32_16x16x32_bf16 v[24:27], v[64:67], v[48:51], v[24:27]
    ds_read_b128 v[48:51], v6 offset:64
    v_add_f32_dpp v14, v14, v14 row_ror:2 row_mask:0xf bank_mask:0xf
    s_waitcnt lgkmcnt(6)
    v_mfma_f32_16x16x32_bf16 v[24:27], v[68:71], v[52:55], v[24:27]
    ds_read_b128 v[52:55], v6 offset:192
    v_add_f32_dpp v14, v14, v14 row_ror:1 row_mask:0xf bank_mask:0xf
    s_waitcnt lgkmcnt(6)
    v_mfma_f32_16x16x32_bf16 v[24:27], v[72:75], v[28:31], v[24:27]
    ds_read_b128 v[28:31], v6 offset:320
    v_mov_b32 v15, v14
    s_waitcnt lgkmcnt(6)
    v_mfma_f32_16x16x32_bf16 v[24:27], v[76:79], v[32:35], v[24:27]
    ds_read_b128 v[32:35], v6 offset:448
    v_permlane16_swap_b32 v14, v15
    s_waitcnt lgkmcnt(6)
    v_mfma_f32_16x16x32_bf16 v[24:27], v[80:83], v[36:39], v[24:27]
    ds_read_b128 v[36:39], v6 offset:576
    v_mul_f32 v14, 0x3ae38e39, v14
    v_mul_f32 v15, 0x3ae38e39, v15
    s_waitcnt lgkmcnt(6)
    v_mfma_f32_16x16x32_bf16 v[24:27], v[84:87], v[40:43], v[24:27]
    ds_read_b128 v[40:43], v6 offset:704
    v_fma_f32 v15, -v14, v14, v15
    v_max_f32 v15, 0, v15
    s_waitcnt lgkmcnt(6)
    v_mfma_f32_16x16x32_bf16 v[24:27], v[88:91], v[44:47], v[24:27]
    ds_read_b128 v[44:47], v6 offset:832
    v_cvt_pk_bf16_f32 v15, v15, v15
    v_and_b32 v15, 0xffff0000, v15
    s_waitcnt lgkmcnt(6)
    v_mfma_f32_16x16x32_bf16 v[24:27], v[92:95], v[48:51], v[24:27]
    ds_read_b128 v[48:51], v6 offset:960
    v_cvt_pk_bf16_f32 v17, v14, v14
    v_and_b32 v17, 0xffff0000, v17
    s_waitcnt lgkmcnt(6)
    v_mfma_f32_16x16x32_bf16 v[24:27], v[96:99], v[52:55], v[24:27]
    ds_read_b128 v[52:55], v6 offset:1088
    v_add_f32 v15, 0x3727c5ac, v15
    v_cvt_pk_bf16_f32 v15, v15, v15
    s_waitcnt lgkmcnt(6)
    v_mfma_f32_16x16x32_bf16 v[24:27], v[100:103], v[28:31], v[24:27]
    v_and_b32 v15, 0xffff0000, v15
    v_sqrt_f32 v15, v15
    s_waitcnt lgkmcnt(5)
    v_mfma_f32_16x16x32_bf16 v[24:27], v[104:107], v[32:35], v[24:27]
    v_cvt_pk_bf16_f32 v18, v15, v15
    v_and_b32 v18, 0xffff0000, v18
    s_waitcnt lgkmcnt(4)
    v_mfma_f32_16x16x32_bf16 v[24:27], v[108:111], v[36:39], v[24:27]
    v_rcp_f32 v19, v18
    s_waitcnt lgkmcnt(3)
    v_mfma_f32_16x16x32_bf16 v[24:27], v[112:115], v[40:43], v[24:27]
    s_waitcnt lgkmcnt(2)
    v_mfma_f32_16x16x32_bf16 v[24:27], v[116:119], v[44:47], v[24:27]
    s_waitcnt lgkmcnt(1)
    v_mfma_f32_16x16x32_bf16 v[24:27], v[120:123], v[48:51], v[24:27]
    s_waitcnt lgkmcnt(0)
    v_mfma_f32_16x16x32_bf16 v[24:27], v[124:127], v[52:55], v[24:27]
    s_nop 7
    v_cndmask_b32 v5, v24, v25, s[72:73]
    v_cndmask_b32 v5, v5, v26, s[74:75]
    v_cndmask_b32 v5, v5, v27, s[76:77]
    s_nop 1
    v_mul_f32_dpp v7, v5, v17 quad_perm:[1,0,3,2] row_mask:0xf bank_mask:0xf
    v_sub_f32 v5, v5, v7
    v_mul_f32 v5, v5, v19
    v_cvt_pk_bf16_f32 v5, v5, v5
    v_and_b32 v5, 0xffff0000, v5
    v_mov_b32 v7, v5
    s_nop 1
    v_permlane32_swap_b32 v5, v7
    v_mul_f32 v9, 0xbfb8aa3b, v5
    v_exp_f32 v9, v9
    s_nop 0
    v_add_f32 v9, 1.0, v9
    v_rcp_f32 v9, v9
    s_nop 0
    v_mul_f32 v5, v5, v9
    v_cvt_pk_bf16_f32 v5, v5, v5
    v_and_b32 v5, 0xffff0000, v5
    v_mul_f32 v5, v5, v7
    v_cvt_pk_bf16_f32 v5, v5, v5
    s_mov_b64 exec, 0x00550055
    ds_write_b16 v12, v5 offset:1088
    s_waitcnt lgkmcnt(0)
    s_barrier
    s_branch Lfin
LFc:
    s_waitcnt vmcnt(0)
    ds_read_b32 v14, v11 offset:64
    ds_read_u16 v56, v13 offset:2816
    ds_read_u16 v57, v13 offset:2944
    ds_read_u16 v58, v13 offset:3072
    ds_read_u16 v59, v13 offset:3200
    ds_read_u16 v60, v13 offset:3328
    ds_read_u16 v61, v13 offset:3456
    ds_read_u16 v62, v13 offset:3584
    ds_read_u16 v63, v13 offset:3712
    ds_read_u16 v64, v13 offset:3840
    ds_read_u16 v65, v12 offset:2816
    s_waitcnt lgkmcnt(0)
    v_add_f32_dpp v14, v14, v14 row_ror:8 row_mask:0xf bank_mask:0xf
    s_nop 1
    v_add_f32_dpp v14, v14, v14 row_ror:4 row_mask:0xf bank_mask:0xf
    s_nop 1
    v_add_f32_dpp v14, v14, v14 row_ror:2 row_mask:0xf bank_mask:0xf
    s_nop 1
    v_add_f32_dpp v14, v14, v14 row_ror:1 row_mask:0xf bank_mask:0xf
    v_mov_b32 v15, v14
    s_nop 1
    v_permlane16_swap_b32 v14, v15
    v_mul_f32 v14, 0x3ae38e39, v14
    v_mul_f32 v15, 0x3ae38e39, v15
    v_fma_f32 v15, -v14, v14, v15
    v_max_f32 v15, 0, v15
    v_cvt_pk_bf16_f32 v15, v15, v15
    v_and_b32 v15, 0xffff0000, v15
    v_cvt_pk_bf16_f32 v17, v14, v14
    v_and_b32 v17, 0xffff0000, v17
    v_add_f32 v15, 0x3727c5ac, v15
    v_cvt_pk_bf16_f32 v15, v15, v15
    v_and_b32 v15, 0xffff0000, v15
    v_sqrt_f32 v15, v15
    s_nop 0
    v_cvt_pk_bf16_f32 v18, v15, v15
    v_and_b32 v18, 0xffff0000, v18
    v_rcp_f32 v19, v18
    v_lshlrev_b32 v56, 16, v56
    v_lshlrev_b32 v57, 16, v57
    v_lshlrev_b32 v58, 16, v58
    v_lshlrev_b32 v59, 16, v59
    v_lshlrev_b32 v60, 16, v60
    v_lshlrev_b32 v61, 16, v61
    v_lshlrev_b32 v62, 16, v62
    v_lshlrev_b32 v63, 16, v63
    v_lshlrev_b32 v64, 16, v64
    v_lshlrev_b32 v65, 16, v65
    v_mov_b32 v20, v65
    v_sub_f32 v56, v56, v17
    v_sub_f32 v57, v57, v17
    v_sub_f32 v58, v58, v17
    v_sub_f32 v59, v59, v17
    v_sub_f32 v60, v60, v17
    v_cvt_pk_bf16_f32 v56, v56, v56
    v_cvt_pk_bf16_f32 v57, v57, v57
    v_cvt_pk_bf16_f32 v58, v58, v58
    v_cvt_pk_bf16_f32 v59, v59, v59
    v_cvt_pk_bf16_f32 v60, v60, v60
    v_and_b32 v56, 0xffff0000, v56
    v_and_b32 v57, 0xffff0000, v57
    v_and_b32 v58, 0xffff0000, v58
    v_and_b32 v59, 0xffff0000, v59
    v_and_b32 v60, 0xffff0000, v60
    v_mul_f32 v68, v56, v19
    v_mul_f32 v69, v57, v19
    v_mul_f32 v70, v58, v19
    v_mul_f32 v71, v59, v19
    v_mul_f32 v72, v60, v19
    v_fma_f32 v56, -v68, v18, v56
    v_fma_f32 v57, -v69, v18, v57
    v_fma_f32 v58, -v70, v18, v58
    v_fma_f32 v59, -v71, v18, v59
    v_fma_f32 v60, -v72, v18, v60
    v_fma_f32 v56, v56, v19, v68
    v_fma_f32 v57, v57, v19, v69
    v_fma_f32 v58, v58, v19, v70
    v_fma_f32 v59, v59, v19, v71
    v_fma_f32 v60, v60, v19, v72
    v_sub_f32 v61, v61, v17
    v_sub_f32 v62, v62, v17
    v_sub_f32 v63, v63, v17
    v_sub_f32 v64, v64, v17
    v_sub_f32 v65, v65, v17
    v_cvt_pk_bf16_f32 v61, v61, v61
    v_cvt_pk_bf16_f32 v62, v62, v62
    v_cvt_pk_bf16_f32 v63, v63, v63
    v_cvt_pk_bf16_f32 v64, v64, v64
    v_cvt_pk_bf16_f32 v65, v65, v65
    v_and_b32 v61, 0xffff0000, v61
    v_and_b32 v62, 0xffff0000, v62
    v_and_b32 v63, 0xffff0000, v63
    v_and_b32 v64, 0xffff0000, v64
    v_and_b32 v65, 0xffff0000, v65
    v_mul_f32 v73, v61, v19
    v_mul_f32 v74, v62, v19
    v_mul_f32 v75, v63, v19
    v_mul_f32 v76, v64, v19
    v_mul_f32 v77, v65, v19
    v_fma_f32 v61, -v73, v18, v61
    v_fma_f32 v62, -v74, v18, v62
    v_fma_f32 v63, -v75, v18, v63
    v_fma_f32 v64, -v76, v18, v64
    v_fma_f32 v65, -v77, v18, v65
    v_fma_f32 v61, v61, v19, v73
    v_fma_f32 v62, v62, v19, v74
    v_fma_f32 v63, v63, v19, v75
    v_fma_f32 v64, v64, v19, v76
    v_fma_f32 v65, v65, v19, v77
    v_cvt_pk_bf16_f32 v56, v56, v56
    v_and_b32 v56, 0xffff0000, v56
    v_cvt_pk_bf16_f32 v57, v57, v57
    v_and_b32 v57, 0xffff0000, v57
    v_cvt_pk_bf16_f32 v58, v58, v58
    v_and_b32 v58, 0xffff0000, v58
    v_cvt_pk_bf16_f32 v59, v59, v59
    v_and_b32 v59, 0xffff0000, v59
    v_cvt_pk_bf16_f32 v60, v60, v60
    v_and_b32 v60, 0xffff0000, v60
    v_cvt_pk_bf16_f32 v61, v61, v61
    v_and_b32 v61, 0xffff0000, v61
    v_cvt_pk_bf16_f32 v62, v62, v62
    v_and_b32 v62, 0xffff0000, v62
    v_cvt_pk_bf16_f32 v63, v63, v63
    v_and_b32 v63, 0xffff0000, v63
    v_cvt_pk_bf16_f32 v64, v64, v64
    v_and_b32 v64, 0xffff0000, v64
    v_cvt_pk_bf16_f32 v65, v65, v65
    v_and_b32 v65, 0xffff0000, v65
    v_lshlrev_b32 v28, 16, v28
    v_lshlrev_b32 v29, 16, v29
    v_lshlrev_b32 v30, 16, v30
    v_lshlrev_b32 v31, 16, v31
    v_lshlrev_b32 v32, 16, v32
    v_lshlrev_b32 v33, 16, v33
    v_lshlrev_b32 v34, 16, v34
    v_lshlrev_b32 v35, 16, v35
    v_lshlrev_b32 v21, 16, v21
    v_mul_f32 v5, v56, v28
    v_fmac_f32 v5, v57, v29
    v_fmac_f32 v5, v58, v30
    v_fmac_f32 v5, v59, v31
    v_fmac_f32 v5, v60, v32
    v_fmac_f32 v5, v61, v33
    v_fmac_f32 v5, v62, v34
    v_fmac_f32 v5, v63, v35
    v_fmac_f32 v5, v64, v21
    s_nop 1
    v_add_f32_dpp v5, v5, v5 row_ror:8 row_mask:0xf bank_mask:0xf
    s_nop 1
    v_add_f32_dpp v5, v5, v5 row_ror:4 row_mask:0xf bank_mask:0xf
    s_nop 1
    v_add_f32_dpp v5, v5, v5 row_ror:2 row_mask:0xf bank_mask:0xf
    s_nop 1
    v_add_f32_dpp v5, v5, v5 row_ror:1 row_mask:0xf bank_mask:0xf
    v_mov_b32 v6, v5
    s_nop 1
    v_permlane16_swap_b32 v5, v6
    v_add_f32 v5, v5, v6
    v_mov_b32 v6, v5
    s_nop 1
    v_permlane32_swap_b32 v5, v6
    v_add_f32 v5, v5, v6
    v_cvt_pk_bf16_f32 v5, v5, v5
    v_and_b32 v5, 0xffff0000, v5
    v_mul_f32 v5, 0xbfb8aa3b, v5
    v_exp_f32 v5, v5
    s_nop 0
    v_add_f32 v5, 1.0, v5
    v_rcp_f32 v21, v5
    s_nop 0
    v_cvt_pk_bf16_f32 v21, v21, v21
    v_and_b32 v21, 0xffff0000, v21
    v_bfe_u32 v9, v1, 2, 1
    v_lshlrev_b32 v9, 4, v9
    v_mov_b32 v10, 0x3f80
    v_lshlrev_b32 v9, v9, v10
    v_bfe_i32 v10, v1, 3, 1
    v_bfi_b32 v68, v10, 0, v9
    v_and_b32 v69, v10, v9
    v_bfe_u32 v13, v1, 2, 1
    v_add3_u32 v13, v13, v1, v2
    v_mul_u32_u24 v13, 2304, v13
    s_lshl_b32 s79, s82, 4
    s_add_u32 s79, s79, 589824
    v_add_u32 v13, s79, v13
    v_add_u32 v14, 165888, v13
    v_mul_u32_u24 v15, 20736, v1
    s_add_u32 s79, s79, 9216
    v_add_u32 v15, s79, v15
    v_mov_b32 v48, 0
    v_mov_b32 v50, 0
Lw_135:
    ds_read_b32 v16, v4 offset:36
    s_waitcnt lgkmcnt(0)
    v_readfirstlane_b32 s78, v16
    s_cmp_ge_u32 s78, 9
    s_cbranch_scc1 Lwk_136
    s_sub_u32 s0, s0, 1
    s_cbranch_scc0 Lw_135
    s_endpgm
Lwk_136:
Lcgo:
    s_mov_b64 s[88:89], -1
    s_mov_b64 s[90:91], -1
    s_mov_b32 s92, 0x0000ffff
    s_mov_b32 s93, 0x00000000
    s_mov_b32 s81, 0x800000
Lcrt_137:
    s_mov_b64 exec, s[88:89]
    s_cbranch_execz Lsk_139
    buffer_load_dwordx4 v[40:43], v13, s[48:51], 0 offen sc1
Lsk_139:
    s_mov_b64 exec, s[90:91]
    s_cbranch_execz Lsk_140
    buffer_load_dwordx4 v[44:47], v14, s[48:51], 0 offen sc1
Lsk_140:
    s_mov_b64 exec, s[92:93]
    s_cbranch_execz Lsk_141
    buffer_load_dwordx4 v[48:51], v15, s[48:51], 0 offen sc1
Lsk_141:
    s_waitcnt vmcnt(0)
    s_mov_b64 exec, s[88:89]
    v_bitop3_b32 v16, v41, v43, s7 bitop3:0x7e
    v_cmp_ne_u32 s[88:89], 0, v16
    s_mov_b64 exec, s[90:91]
    v_bitop3_b32 v16, v45, v47, s7 bitop3:0x7e
    v_cmp_ne_u32 s[90:91], 0, v16
    s_mov_b64 exec, s[92:93]
    v_bitop3_b32 v16, v49, v51, s7 bitop3:0x7e
    v_cmp_ne_u32 s[92:93], 0, v16
    s_mov_b64 exec, -1
    s_or_b64 vcc, s[88:89], s[90:91]
    s_or_b64 vcc, vcc, s[92:93]
    s_cbranch_scc0 Lcok_138
    s_sub_u32 s81, s81, 1
    s_cbranch_scc0 Lcrt_137
Lcok_138:
    v_mov_b32 v41, v42
    v_mov_b32 v45, v46
    v_mov_b32 v49, v50
    v_mfma_f32_16x16x16_bf16 v[24:27], v[68:69], v[40:41], 0
    v_mfma_f32_16x16x16_bf16 v[24:27], v[68:69], v[44:45], v[24:27]
    v_mfma_f32_16x16x16_bf16 v[24:27], v[68:69], v[48:49], v[24:27]
    s_nop 7
    v_add_f32_dpp v24, v24, v24 row_ror:8 row_mask:0xf bank_mask:0xf
    s_nop 1
    v_add_f32_dpp v24, v24, v24 row_ror:4 row_mask:0xf bank_mask:0xf
    s_nop 1
    v_add_f32_dpp v24, v24, v24 row_ror:2 row_mask:0xf bank_mask:0xf
    s_nop 1
    v_add_f32_dpp v24, v24, v24 row_ror:1 row_mask:0xf bank_mask:0xf
    v_cvt_pk_bf16_f32 v24, v24, v24
    v_and_b32 v24, 0xffff0000, v24
    v_mul_f32 v24, v24, v21
    v_cvt_pk_bf16_f32 v24, v24, v24
    v_and_b32 v24, 0xffff0000, v24
    v_add_f32 v24, v24, v65
    v_cvt_pk_bf16_f32 v24, v24, v24
    v_and_b32 v24, 0xffff0000, v24
    v_add_f32 v24, v24, v20
    v_cvt_pk_bf16_f32 v24, v24, v24
    s_mov_b32 exec_lo, 0x00010001
    s_mov_b32 exec_hi, 0x00010001
    buffer_store_short v24, v12, s[60:63], 0 offen
    s_cmp_lg_u32 s82, 0
    s_cbranch_scc1 Lfin
    s_mov_b64 exec, 1
    v_mov_b32 v6, s7
    buffer_store_dword v6, v4, s[48:51], 0 offen
    s_branch Lfin
LFg:
    s_sub_u32 s86, s3, 4
    s_lshl_b32 s79, s86, 7
    v_lshl_add_u32 v12, v1, 1, s79
    v_lshrrev_b32 v7, 4, v1
    v_mul_u32_u24 v13, 4608, v7
    v_and_b32 v8, 15, v1
    v_lshl_add_u32 v13, v8, 4, v13
    v_and_b32 v14, 12, v1
    v_lshl_add_u32 v13, v14, 4, v13
    s_lshl_b32 s78, s86, 9
    s_lshl_b32 s80, s86, 8
    s_add_u32 s78, s78, 1572864
    s_lshl_b32 s81, s87, 16
    v_add_u32 v13, s78, v13
    v_add_u32 v14, 18432, v13
    v_bfe_u32 v11, v1, 2, 2
    v_lshl_add_u32 v11, v7, 3, v11
    v_lshlrev_b32 v11, 7, v11
    v_and_b32 v15, 3, v1
    v_lshl_add_u32 v11, v15, 3, v11
    v_bfe_u32 v5, v1, 3, 2
    v_lshl_add_u32 v11, v5, 5, v11
    s_lshl_b32 s79, s86, 12
    s_add_u32 s79, s79, 86016
    v_add_u32 v11, s79, v11
    v_lshl_add_u32 v20, v8, 2, v7
    v_lshlrev_b32 v18, 4, v20
    v_lshlrev_b32 v5, 4, v7
    v_add_u32 v5, 1088, v5
    v_mov_b32 v6, 192
    v_cmp_eq_u32 vcc, 0, v15
    s_nop 1
    v_cndmask_b32 v72, v6, v5, vcc
    v_cmp_eq_u32 vcc, 1, v15
    s_nop 1
    v_cndmask_b32 v73, v6, v5, vcc
    v_cmp_eq_u32 vcc, 2, v15
    s_nop 1
    v_cndmask_b32 v74, v6, v5, vcc
    v_cmp_eq_u32 vcc, 3, v15
    s_nop 1
    v_cndmask_b32 v75, v6, v5, vcc
    s_lshl_b32 s78, s86, 2
    v_lshl_add_u32 v17, v1, 2, s78
    s_mul_i32 s79, s82, 2304
    s_add_u32 s79, s79, s80
    s_add_u32 s83, s79, 589824
    v_mov_b32 v29, s7
    v_mov_b32 v31, s7
    v_and_b32 v9, 1, v1
    v_lshlrev_b32 v9, 4, v9
    v_mov_b32 v10, 0x3f80
    v_lshlrev_b32 v9, v9, v10
    v_bfe_i32 v10, v1, 1, 1
    v_bfi_b32 v76, v10, 0, v9
    v_and_b32 v77, v10, v9
    v_mov_b32 v78, v76
    v_mov_b32 v79, v77
    s_mov_b32 s72, 0x00f000f0
    s_mov_b32 s73, 0x00f000f0
    s_mov_b32 s74, 0x0f000f00
    s_mov_b32 s75, 0x0f000f00
    s_mov_b32 s76, 0xf000f000
    s_mov_b32 s77, 0xf000f000
    s_lshl_b32 s79, s87, 12
    s_mul_i32 s80, s86, 384
    s_add_u32 s79, s79, s80
    s_add_u32 s79, s79, 229376
    v_lshl_add_u32 v13, v1, 4, s79
    s_lshl_b32 s79, s86, 7
    s_add_u32 s79, s79, 2816
    v_lshl_add_u32 v12, v1, 3, s79
    s_lshl_b32 s79, s86, 3
    s_add_u32 s79, s79, 64
    v_writelane_b32 v12, s79, 16
    v_xor_b32 v80, 0, v11
    v_xor_b32 v81, 32, v11
    v_xor_b32 v82, 64, v11
    v_xor_b32 v83, 96, v11
    s_cmp_ge_u32 s85, 216
    s_cbranch_scc1 Lpg_142
Lw_143:
    ds_read_b32 v16, v4 offset:0
    s_waitcnt lgkmcnt(0)
    v_readfirstlane_b32 s85, v16
    s_cmp_ge_u32 s85, 216
    s_cbranch_scc1 Lwk_144
    s_sleep 1
    s_sub_u32 s0, s0, 1
    s_cbranch_scc0 Lw_143
    s_endpgm
Lwk_144:
Lpg_142:
    ds_read_b64_tr_b16 v[56:57], v80
    ds_read_b64_tr_b16 v[58:59], v80 offset:512
    ds_read_b64_tr_b16 v[60:61], v81
    ds_read_b64_tr_b16 v[62:63], v81 offset:512
    ds_read_b64_tr_b16 v[64:65], v82
    ds_read_b64_tr_b16 v[66:67], v82 offset:512
    ds_read_b64_tr_b16 v[68:69], v83
    ds_read_b64_tr_b16 v[70:71], v83 offset:512
    s_cmp_ge_u32 s85, 216
    s_cbranch_scc1 Lpg_145
Lw_146:
    ds_read_b32 v16, v4 offset:0
    s_waitcnt lgkmcnt(0)
    v_readfirstlane_b32 s85, v16
    s_cmp_ge_u32 s85, 216
    s_cbranch_scc1 Lwk_147
    s_sleep 1
    s_sub_u32 s0, s0, 1
    s_cbranch_scc0 Lw_146
    s_endpgm
Lwk_147:
Lpg_145:
    s_setprio 2
    s_mov_b32 s88, 0x0001ffff
    s_mov_b32 s89, 0x00000000
    s_mov_b32 s1, 1048576
    s_mov_b32 s81, 0x800000
Lbrt_148:
    s_mov_b64 exec, s[88:89]
    s_cbranch_execz Lsk_150
    buffer_load_dwordx4 v[40:43], v13, s[48:51], s1 offen sc1
Lsk_150:
    s_waitcnt vmcnt(0)
    s_mov_b64 exec, s[88:89]
    v_bitop3_b32 v16, v41, v43, s7 bitop3:0x7e
    v_cmp_ne_u32 s[88:89], 0, v16
    s_mov_b64 exec, -1
    s_cmp_eq_u64 s[88:89], 0
    s_cbranch_scc1 Lbok_149
    s_cmp_lt_u32 s81, 0x7fffc1
    s_cselect_b32 s78, 1048576, 0
    s_xor_b32 s1, s1, s78
    s_sub_u32 s81, s81, 1
    s_cbranch_scc0 Lbrt_148
Lbok_149:
    s_mov_b64 exec, 0x1ffff
    ds_write2_b32 v12, v40, v42 offset0:0 offset1:1
    v_mov_b32 v16, 1
    s_mov_b64 exec, 1
    ds_add_u32 v4, v16 offset:40
    s_mov_b64 exec, -1
    s_mov_b64 exec, -1
    s_waitcnt lgkmcnt(0)
    s_barrier
    s_waitcnt lgkmcnt(0)
    s_barrier
    ds_read_b128 v[40:43], v72
    ds_read_b128 v[44:47], v73
    ds_read_b128 v[48:51], v74
    ds_read_b128 v[52:55], v75
    s_waitcnt lgkmcnt(3)
    v_mfma_f32_16x16x32_bf16 v[24:27], v[56:59], v[40:43], 0
    s_waitcnt lgkmcnt(2)
    v_mfma_f32_16x16x32_bf16 v[24:27], v[60:63], v[44:47], v[24:27]
    s_waitcnt lgkmcnt(1)
    v_mfma_f32_16x16x32_bf16 v[24:27], v[64:67], v[48:51], v[24:27]
    s_waitcnt lgkmcnt(0)
    v_mfma_f32_16x16x32_bf16 v[24:27], v[68:71], v[52:55], v[24:27]
    s_mov_b32 exec_lo, 0x000f000f
    s_mov_b32 exec_hi, 0x000f000f
    s_nop 5
    v_cvt_pk_bf16_f32 v28, v24, v25
    v_cvt_pk_bf16_f32 v30, v26, v27
    buffer_store_dwordx4 v[28:31], v18, s[48:51], s83 offen sc1
    s_waitcnt vmcnt(0)
    v_mov_b32 v16, 1
    s_mov_b64 exec, 1
    ds_add_u32 v4, v16 offset:36
    s_mov_b64 exec, -1
    s_branch Lfin
Lloader:
    s_barrier
    s_mov_b32 m0, 28672
    s_add_u32 s79, s76, 16384
    s_cmp_ge_u32 s79, s77
    s_cselect_b32 s78, s77, 0
    s_sub_u32 s79, s79, s78
    buffer_load_dwordx4 v5, s[36:39], s79 offen offset:0 nt lds
    buffer_load_dwordx4 v5, s[36:39], s79 offen offset:1024 nt lds
    buffer_load_dwordx4 v5, s[36:39], s79 offen offset:2048 nt lds
    buffer_load_dwordx4 v5, s[36:39], s79 offen offset:3072 nt lds
    s_mov_b32 s88, s16
    s_mov_b32 s89, s17
    s_mov_b32 s90, s26
    s_mov_b32 s91, s27
    s_mov_b32 s32, s8
    s_mov_b32 s33, s9
    s_movk_i32 s34, 1152
    s_mov_b32 s35, 0x20000
    s_cmp_eq_u32 s84, 2
    s_cselect_b32 s52, s16, s26
    s_cselect_b32 s53, s17, s27
    s_mov_b32 s80, 4718592
    s_cselect_b32 s54, s80, 5308416
    s_mov_b32 s55, 0x20000
    s_mov_b32 s64, s22
    s_mov_b32 s65, s23
    s_mov_b32 s66, 5308416
    s_mov_b32 s67, 0x20000
    s_mov_b32 s68, s24
    s_mov_b32 s69, s25
    s_mov_b32 s70, 5308416
    s_mov_b32 s71, 0x20000
    s_mov_b32 s48, s30
    s_mov_b32 s49, s31
    s_mov_b32 s50, 4194304
    s_mov_b32 s51, 0x20000
    s_mov_b32 s56, s20
    s_mov_b32 s57, s21
    s_movk_i32 s58, 1152
    s_mov_b32 s59, 0x20000
    s_mov_b32 s60, s28
    s_mov_b32 s61, s29
    s_movk_i32 s62, 1152
    s_mov_b32 s63, 0x20000
    s_cmp_eq_u32 s84, 2
    s_cbranch_scc1 LloadW
    s_mov_b32 m0, 32768
    s_add_u32 s79, s76, 20480
    s_cmp_ge_u32 s79, s77
    s_cselect_b32 s78, s77, 0
    s_sub_u32 s79, s79, s78
    buffer_load_dwordx4 v5, s[36:39], s79 offen offset:0 nt lds
    buffer_load_dwordx4 v5, s[36:39], s79 offen offset:1024 nt lds
    buffer_load_dwordx4 v5, s[36:39], s79 offen offset:2048 nt lds
    buffer_load_dwordx4 v5, s[36:39], s79 offen offset:3072 nt lds
    s_mov_b32 m0, 36864
    s_add_u32 s79, s76, 24576
    s_cmp_ge_u32 s79, s77
    s_cselect_b32 s78, s77, 0
    s_sub_u32 s79, s79, s78
    buffer_load_dwordx4 v5, s[36:39], s79 offen offset:0 nt lds
    s_waitcnt vmcnt(24)
    buffer_load_dwordx4 v5, s[36:39], s79 offen offset:1024 nt lds
    s_waitcnt vmcnt(24)
    buffer_load_dwordx4 v5, s[36:39], s79 offen offset:2048 nt lds
    s_waitcnt vmcnt(24)
    buffer_load_dwordx4 v5, s[36:39], s79 offen offset:3072 nt lds
    s_waitcnt vmcnt(24)
    s_mov_b32 m0, 40960
    s_add_u32 s79, s76, 28672
    s_cmp_ge_u32 s79, s77
    s_cselect_b32 s78, s77, 0
    s_sub_u32 s79, s79, s78
    buffer_load_dwordx4 v5, s[36:39], s79 offen offset:0 nt lds
    s_waitcnt vmcnt(24)
    buffer_load_dwordx4 v5, s[36:39], s79 offen offset:1024 nt lds
    s_waitcnt vmcnt(24)
    buffer_load_dwordx4 v5, s[36:39], s79 offen offset:2048 nt lds
    s_waitcnt vmcnt(24)
    buffer_load_dwordx4 v5, s[36:39], s79 offen offset:3072 nt lds
    s_waitcnt vmcnt(24)
    v_mov_b32 v11, 8
    s_mov_b64 exec, 1
    ds_write_b32 v4, v11 offset:0
    s_mov_b64 exec, -1
    s_mov_b32 m0, 45056
    s_add_u32 s79, s76, 32768
    s_cmp_ge_u32 s79, s77
    s_cselect_b32 s78, s77, 0
    s_sub_u32 s79, s79, s78
    buffer_load_dwordx4 v5, s[36:39], s79 offen offset:0 nt lds
    s_waitcnt vmcnt(24)
    buffer_load_dwordx4 v5, s[36:39], s79 offen offset:1024 nt lds
    s_waitcnt vmcnt(24)
    buffer_load_dwordx4 v5, s[36:39], s79 offen offset:2048 nt lds
    s_waitcnt vmcnt(24)
    buffer_load_dwordx4 v5, s[36:39], s79 offen offset:3072 nt lds
    s_waitcnt vmcnt(24)
    s_mov_b32 m0, 49152
    s_add_u32 s79, s76, 36864
    s_cmp_ge_u32 s79, s77
    s_cselect_b32 s78, s77, 0
    s_sub_u32 s79, s79, s78
    buffer_load_dwordx4 v5, s[36:39], s79 offen offset:0 nt lds
    s_waitcnt vmcnt(24)
    buffer_load_dwordx4 v5, s[36:39], s79 offen offset:1024 nt lds
    s_waitcnt vmcnt(24)
    buffer_load_dwordx4 v5, s[36:39], s79 offen offset:2048 nt lds
    s_waitcnt vmcnt(24)
    buffer_load_dwordx4 v5, s[36:39], s79 offen offset:3072 nt lds
    s_waitcnt vmcnt(24)
    v_mov_b32 v11, 16
    s_mov_b64 exec, 1
    ds_write_b32 v4, v11 offset:0
    s_mov_b64 exec, -1
    s_mov_b32 m0, 53248
    s_add_u32 s79, s76, 40960
    s_cmp_ge_u32 s79, s77
    s_cselect_b32 s78, s77, 0
    s_sub_u32 s79, s79, s78
    buffer_load_dwordx4 v5, s[36:39], s79 offen offset:0 nt lds
    s_waitcnt vmcnt(24)
    buffer_load_dwordx4 v5, s[36:39], s79 offen offset:1024 nt lds
    s_waitcnt vmcnt(24)
    buffer_load_dwordx4 v5, s[36:39], s79 offen offset:2048 nt lds
    s_waitcnt vmcnt(24)
    buffer_load_dwordx4 v5, s[36:39], s79 offen offset:3072 nt lds
    s_waitcnt vmcnt(24)
    s_mov_b32 m0, 57344
    s_add_u32 s79, s76, 45056
    s_cmp_ge_u32 s79, s77
    s_cselect_b32 s78, s77, 0
    s_sub_u32 s79, s79, s78
    buffer_load_dwordx4 v5, s[36:39], s79 offen offset:0 nt lds
    s_waitcnt vmcnt(24)
    buffer_load_dwordx4 v5, s[36:39], s79 offen offset:1024 nt lds
    s_waitcnt vmcnt(24)
    buffer_load_dwordx4 v5, s[36:39], s79 offen offset:2048 nt lds
    s_waitcnt vmcnt(24)
    buffer_load_dwordx4 v5, s[36:39], s79 offen offset:3072 nt lds
    s_waitcnt vmcnt(24)
    v_mov_b32 v11, 24
    s_mov_b64 exec, 1
    ds_write_b32 v4, v11 offset:0
    s_mov_b64 exec, -1
    s_mov_b32 m0, 61440
    s_add_u32 s79, s76, 49152
    s_cmp_ge_u32 s79, s77
    s_cselect_b32 s78, s77, 0
    s_sub_u32 s79, s79, s78
    buffer_load_dwordx4 v5, s[36:39], s79 offen offset:0 nt lds
    s_waitcnt vmcnt(24)
    buffer_load_dwordx4 v5, s[36:39], s79 offen offset:1024 nt lds
    s_waitcnt vmcnt(24)
    buffer_load_dwordx4 v5, s[36:39], s79 offen offset:2048 nt lds
    s_waitcnt vmcnt(24)
    buffer_load_dwordx4 v5, s[36:39], s79 offen offset:3072 nt lds
    s_waitcnt vmcnt(24)
    s_mov_b32 m0, 65536
    s_add_u32 s79, s76, 53248
    s_cmp_ge_u32 s79, s77
    s_cselect_b32 s78, s77, 0
    s_sub_u32 s79, s79, s78
    buffer_load_dwordx4 v5, s[36:39], s79 offen offset:0 nt lds
    s_waitcnt vmcnt(24)
    buffer_load_dwordx4 v5, s[36:39], s79 offen offset:1024 nt lds
    s_waitcnt vmcnt(24)
    buffer_load_dwordx4 v5, s[36:39], s79 offen offset:2048 nt lds
    s_waitcnt vmcnt(24)
    buffer_load_dwordx4 v5, s[36:39], s79 offen offset:3072 nt lds
    s_waitcnt vmcnt(24)
    v_mov_b32 v11, 32
    s_mov_b64 exec, 1
    ds_write_b32 v4, v11 offset:0
    s_mov_b64 exec, -1
    s_mov_b32 m0, 69632
    s_add_u32 s79, s76, 57344
    s_cmp_ge_u32 s79, s77
    s_cselect_b32 s78, s77, 0
    s_sub_u32 s79, s79, s78
    buffer_load_dwordx4 v5, s[36:39], s79 offen offset:0 nt lds
    s_waitcnt vmcnt(24)
    buffer_load_dwordx4 v5, s[36:39], s79 offen offset:1024 nt lds
    s_waitcnt vmcnt(24)
    buffer_load_dwordx4 v5, s[36:39], s79 offen offset:2048 nt lds
    s_waitcnt vmcnt(24)
    buffer_load_dwordx4 v5, s[36:39], s79 offen offset:3072 nt lds
    s_waitcnt vmcnt(24)
    s_mov_b32 m0, 73728
    s_add_u32 s79, s76, 61440
    s_cmp_ge_u32 s79, s77
    s_cselect_b32 s78, s77, 0
    s_sub_u32 s79, s79, s78
    buffer_load_dwordx4 v5, s[36:39], s79 offen offset:0 nt lds
    s_waitcnt vmcnt(24)
    buffer_load_dwordx4 v5, s[36:39], s79 offen offset:1024 nt lds
    s_waitcnt vmcnt(24)
    buffer_load_dwordx4 v5, s[36:39], s79 offen offset:2048 nt lds
    s_waitcnt vmcnt(24)
    buffer_load_dwordx4 v5, s[36:39], s79 offen offset:3072 nt lds
    s_waitcnt vmcnt(24)
    v_mov_b32 v11, 40
    s_mov_b64 exec, 1
    ds_write_b32 v4, v11 offset:0
    s_mov_b64 exec, -1
    s_mov_b32 m0, 77824
    s_add_u32 s79, s76, 65536
    s_cmp_ge_u32 s79, s77
    s_cselect_b32 s78, s77, 0
    s_sub_u32 s79, s79, s78
    buffer_load_dwordx4 v5, s[36:39], s79 offen offset:0 nt lds
    s_waitcnt vmcnt(24)
    buffer_load_dwordx4 v5, s[36:39], s79 offen offset:1024 nt lds
    s_waitcnt vmcnt(24)
    buffer_load_dwordx4 v5, s[36:39], s79 offen offset:2048 nt lds
    s_waitcnt vmcnt(24)
    buffer_load_dwordx4 v5, s[36:39], s79 offen offset:3072 nt lds
    s_waitcnt vmcnt(24)
    s_mov_b32 m0, 81920
    s_add_u32 s79, s76, 69632
    s_cmp_ge_u32 s79, s77
    s_cselect_b32 s78, s77, 0
    s_sub_u32 s79, s79, s78
    buffer_load_dwordx4 v5, s[36:39], s79 offen offset:0 nt lds
    s_waitcnt vmcnt(24)
    buffer_load_dwordx4 v5, s[36:39], s79 offen offset:1024 nt lds
    s_waitcnt vmcnt(24)
    buffer_load_dwordx4 v5, s[36:39], s79 offen offset:2048 nt lds
    s_waitcnt vmcnt(24)
    buffer_load_dwordx4 v5, s[36:39], s79 offen offset:3072 nt lds
    s_waitcnt vmcnt(24)
    v_mov_b32 v11, 48
    s_mov_b64 exec, 1
    ds_write_b32 v4, v11 offset:0
    s_mov_b64 exec, -1
    s_mov_b32 m0, 86016
    s_add_u32 s79, s76, 0
    s_cmp_ge_u32 s79, s77
    s_cselect_b32 s78, s77, 0
    s_sub_u32 s79, s79, s78
    buffer_load_dwordx4 v6, s[40:43], s79 offen offset:0 nt lds
    s_waitcnt vmcnt(24)
    buffer_load_dwordx4 v6, s[40:43], s79 offen offset:1024 nt lds
    s_waitcnt vmcnt(24)
    buffer_load_dwordx4 v7, s[40:43], s79 offen offset:2048 nt lds
    s_waitcnt vmcnt(24)
    buffer_load_dwordx4 v7, s[40:43], s79 offen offset:3072 nt lds
    s_waitcnt vmcnt(24)
    s_mov_b32 m0, 90112
    s_add_u32 s79, s76, 4096
    s_cmp_ge_u32 s79, s77
    s_cselect_b32 s78, s77, 0
    s_sub_u32 s79, s79, s78
    buffer_load_dwordx4 v6, s[40:43], s79 offen offset:0 nt lds
    s_waitcnt vmcnt(24)
    buffer_load_dwordx4 v6, s[40:43], s79 offen offset:1024 nt lds
    s_waitcnt vmcnt(24)
    buffer_load_dwordx4 v7, s[40:43], s79 offen offset:2048 nt lds
    s_waitcnt vmcnt(24)
    buffer_load_dwordx4 v7, s[40:43], s79 offen offset:3072 nt lds
    s_waitcnt vmcnt(24)
    v_mov_b32 v11, 56
    s_mov_b64 exec, 1
    ds_write_b32 v4, v11 offset:0
    s_mov_b64 exec, -1
    s_mov_b32 m0, 94208
    s_add_u32 s79, s76, 8192
    s_cmp_ge_u32 s79, s77
    s_cselect_b32 s78, s77, 0
    s_sub_u32 s79, s79, s78
    buffer_load_dwordx4 v6, s[40:43], s79 offen offset:0 nt lds
    s_waitcnt vmcnt(24)
    buffer_load_dwordx4 v6, s[40:43], s79 offen offset:1024 nt lds
    s_waitcnt vmcnt(24)
    buffer_load_dwordx4 v7, s[40:43], s79 offen offset:2048 nt lds
    s_waitcnt vmcnt(24)
    buffer_load_dwordx4 v7, s[40:43], s79 offen offset:3072 nt lds
    s_waitcnt vmcnt(24)
    s_mov_b32 m0, 98304
    s_add_u32 s79, s76, 12288
    s_cmp_ge_u32 s79, s77
    s_cselect_b32 s78, s77, 0
    s_sub_u32 s79, s79, s78
    buffer_load_dwordx4 v6, s[40:43], s79 offen offset:0 nt lds
    s_waitcnt vmcnt(24)
    buffer_load_dwordx4 v6, s[40:43], s79 offen offset:1024 nt lds
    s_waitcnt vmcnt(24)
    buffer_load_dwordx4 v7, s[40:43], s79 offen offset:2048 nt lds
    s_waitcnt vmcnt(24)
    buffer_load_dwordx4 v7, s[40:43], s79 offen offset:3072 nt lds
    s_waitcnt vmcnt(24)
    v_mov_b32 v11, 64
    s_mov_b64 exec, 1
    ds_write_b32 v4, v11 offset:0
    s_mov_b64 exec, -1
    s_mov_b32 m0, 102400
    s_add_u32 s79, s76, 16384
    s_cmp_ge_u32 s79, s77
    s_cselect_b32 s78, s77, 0
    s_sub_u32 s79, s79, s78
    buffer_load_dwordx4 v6, s[40:43], s79 offen offset:0 nt lds
    s_waitcnt vmcnt(24)
    buffer_load_dwordx4 v6, s[40:43], s79 offen offset:1024 nt lds
    s_waitcnt vmcnt(24)
    buffer_load_dwordx4 v7, s[40:43], s79 offen offset:2048 nt lds
    s_waitcnt vmcnt(24)
    buffer_load_dwordx4 v7, s[40:43], s79 offen offset:3072 nt lds
    s_waitcnt vmcnt(24)
    s_mov_b32 m0, 106496
    s_add_u32 s79, s76, 20480
    s_cmp_ge_u32 s79, s77
    s_cselect_b32 s78, s77, 0
    s_sub_u32 s79, s79, s78
    buffer_load_dwordx4 v6, s[40:43], s79 offen offset:0 nt lds
    s_waitcnt vmcnt(24)
    buffer_load_dwordx4 v6, s[40:43], s79 offen offset:1024 nt lds
    s_waitcnt vmcnt(24)
    buffer_load_dwordx4 v7, s[40:43], s79 offen offset:2048 nt lds
    s_waitcnt vmcnt(24)
    buffer_load_dwordx4 v7, s[40:43], s79 offen offset:3072 nt lds
    s_waitcnt vmcnt(24)
    v_mov_b32 v11, 72
    s_mov_b64 exec, 1
    ds_write_b32 v4, v11 offset:0
    s_mov_b64 exec, -1
    s_mov_b32 m0, 110592
    s_add_u32 s79, s76, 24576
    s_cmp_ge_u32 s79, s77
    s_cselect_b32 s78, s77, 0
    s_sub_u32 s79, s79, s78
    buffer_load_dwordx4 v6, s[40:43], s79 offen offset:0 nt lds
    s_waitcnt vmcnt(24)
    buffer_load_dwordx4 v6, s[40:43], s79 offen offset:1024 nt lds
    s_waitcnt vmcnt(24)
    buffer_load_dwordx4 v7, s[40:43], s79 offen offset:2048 nt lds
    s_waitcnt vmcnt(24)
    buffer_load_dwordx4 v7, s[40:43], s79 offen offset:3072 nt lds
    s_waitcnt vmcnt(24)
    s_mov_b32 m0, 114688
    s_add_u32 s79, s76, 28672
    s_cmp_ge_u32 s79, s77
    s_cselect_b32 s78, s77, 0
    s_sub_u32 s79, s79, s78
    buffer_load_dwordx4 v6, s[40:43], s79 offen offset:0 nt lds
    s_waitcnt vmcnt(24)
    buffer_load_dwordx4 v6, s[40:43], s79 offen offset:1024 nt lds
    s_waitcnt vmcnt(24)
    buffer_load_dwordx4 v7, s[40:43], s79 offen offset:2048 nt lds
    s_waitcnt vmcnt(24)
    buffer_load_dwordx4 v7, s[40:43], s79 offen offset:3072 nt lds
    s_waitcnt vmcnt(24)
    v_mov_b32 v11, 80
    s_mov_b64 exec, 1
    ds_write_b32 v4, v11 offset:0
    s_mov_b64 exec, -1
    s_mov_b32 m0, 118784
    s_add_u32 s79, s76, 32768
    s_cmp_ge_u32 s79, s77
    s_cselect_b32 s78, s77, 0
    s_sub_u32 s79, s79, s78
    buffer_load_dwordx4 v6, s[40:43], s79 offen offset:0 nt lds
    s_waitcnt vmcnt(24)
    buffer_load_dwordx4 v6, s[40:43], s79 offen offset:1024 nt lds
    s_waitcnt vmcnt(24)
    buffer_load_dwordx4 v7, s[40:43], s79 offen offset:2048 nt lds
    s_waitcnt vmcnt(24)
    buffer_load_dwordx4 v7, s[40:43], s79 offen offset:3072 nt lds
    s_waitcnt vmcnt(24)
    s_mov_b32 m0, 122880
    s_add_u32 s79, s76, 36864
    s_cmp_ge_u32 s79, s77
    s_cselect_b32 s78, s77, 0
    s_sub_u32 s79, s79, s78
    buffer_load_dwordx4 v6, s[40:43], s79 offen offset:0 nt lds
    s_waitcnt vmcnt(24)
    buffer_load_dwordx4 v6, s[40:43], s79 offen offset:1024 nt lds
    s_waitcnt vmcnt(24)
    buffer_load_dwordx4 v7, s[40:43], s79 offen offset:2048 nt lds
    s_waitcnt vmcnt(24)
    buffer_load_dwordx4 v7, s[40:43], s79 offen offset:3072 nt lds
    s_waitcnt vmcnt(24)
    v_mov_b32 v11, 88
    s_mov_b64 exec, 1
    ds_write_b32 v4, v11 offset:0
    s_mov_b64 exec, -1
    s_mov_b32 m0, 126976
    s_add_u32 s79, s76, 40960
    s_cmp_ge_u32 s79, s77
    s_cselect_b32 s78, s77, 0
    s_sub_u32 s79, s79, s78
    buffer_load_dwordx4 v6, s[40:43], s79 offen offset:0 nt lds
    s_waitcnt vmcnt(24)
    buffer_load_dwordx4 v6, s[40:43], s79 offen offset:1024 nt lds
    s_waitcnt vmcnt(24)
    buffer_load_dwordx4 v7, s[40:43], s79 offen offset:2048 nt lds
    s_waitcnt vmcnt(24)
    buffer_load_dwordx4 v7, s[40:43], s79 offen offset:3072 nt lds
    s_waitcnt vmcnt(24)
    s_mov_b32 m0, 131072
    s_add_u32 s79, s76, 45056
    s_cmp_ge_u32 s79, s77
    s_cselect_b32 s78, s77, 0
    s_sub_u32 s79, s79, s78
    buffer_load_dwordx4 v6, s[40:43], s79 offen offset:0 nt lds
    s_waitcnt vmcnt(24)
    buffer_load_dwordx4 v6, s[40:43], s79 offen offset:1024 nt lds
    s_waitcnt vmcnt(24)
    buffer_load_dwordx4 v7, s[40:43], s79 offen offset:2048 nt lds
    s_waitcnt vmcnt(24)
    buffer_load_dwordx4 v7, s[40:43], s79 offen offset:3072 nt lds
    s_waitcnt vmcnt(24)
    v_mov_b32 v11, 96
    s_mov_b64 exec, 1
    ds_write_b32 v4, v11 offset:0
    s_mov_b64 exec, -1
    s_mov_b32 m0, 135168
    s_add_u32 s79, s76, 49152
    s_cmp_ge_u32 s79, s77
    s_cselect_b32 s78, s77, 0
    s_sub_u32 s79, s79, s78
    buffer_load_dwordx4 v6, s[40:43], s79 offen offset:0 nt lds
    s_waitcnt vmcnt(24)
    buffer_load_dwordx4 v6, s[40:43], s79 offen offset:1024 nt lds
    s_waitcnt vmcnt(24)
    buffer_load_dwordx4 v7, s[40:43], s79 offen offset:2048 nt lds
    s_waitcnt vmcnt(24)
    buffer_load_dwordx4 v7, s[40:43], s79 offen offset:3072 nt lds
    s_waitcnt vmcnt(24)
    s_mov_b32 m0, 139264
    s_add_u32 s79, s76, 53248
    s_cmp_ge_u32 s79, s77
    s_cselect_b32 s78, s77, 0
    s_sub_u32 s79, s79, s78
    buffer_load_dwordx4 v6, s[40:43], s79 offen offset:0 nt lds
    s_waitcnt vmcnt(24)
    buffer_load_dwordx4 v6, s[40:43], s79 offen offset:1024 nt lds
    s_waitcnt vmcnt(24)
    buffer_load_dwordx4 v7, s[40:43], s79 offen offset:2048 nt lds
    s_waitcnt vmcnt(24)
    buffer_load_dwordx4 v7, s[40:43], s79 offen offset:3072 nt lds
    s_waitcnt vmcnt(24)
    v_mov_b32 v11, 104
    s_mov_b64 exec, 1
    ds_write_b32 v4, v11 offset:0
    s_mov_b64 exec, -1
    s_mov_b32 m0, 143360
    s_add_u32 s79, s76, 57344
    s_cmp_ge_u32 s79, s77
    s_cselect_b32 s78, s77, 0
    s_sub_u32 s79, s79, s78
    buffer_load_dwordx4 v6, s[40:43], s79 offen offset:0 nt lds
    s_waitcnt vmcnt(24)
    buffer_load_dwordx4 v6, s[40:43], s79 offen offset:1024 nt lds
    s_waitcnt vmcnt(24)
    buffer_load_dwordx4 v7, s[40:43], s79 offen offset:2048 nt lds
    s_waitcnt vmcnt(24)
    buffer_load_dwordx4 v7, s[40:43], s79 offen offset:3072 nt lds
    s_waitcnt vmcnt(24)
    s_mov_b32 m0, 147456
    s_add_u32 s79, s76, 61440
    s_cmp_ge_u32 s79, s77
    s_cselect_b32 s78, s77, 0
    s_sub_u32 s79, s79, s78
    buffer_load_dwordx4 v6, s[40:43], s79 offen offset:0 nt lds
    s_waitcnt vmcnt(24)
    buffer_load_dwordx4 v6, s[40:43], s79 offen offset:1024 nt lds
    s_waitcnt vmcnt(24)
    buffer_load_dwordx4 v7, s[40:43], s79 offen offset:2048 nt lds
    s_waitcnt vmcnt(24)
    buffer_load_dwordx4 v7, s[40:43], s79 offen offset:3072 nt lds
    s_waitcnt vmcnt(24)
    v_mov_b32 v11, 112
    s_mov_b64 exec, 1
    ds_write_b32 v4, v11 offset:0
    s_mov_b64 exec, -1
    s_mov_b32 m0, 151552
    s_add_u32 s79, s76, 65536
    s_cmp_ge_u32 s79, s77
    s_cselect_b32 s78, s77, 0
    s_sub_u32 s79, s79, s78
    buffer_load_dwordx4 v6, s[40:43], s79 offen offset:0 nt lds
    s_waitcnt vmcnt(24)
    buffer_load_dwordx4 v6, s[40:43], s79 offen offset:1024 nt lds
    s_waitcnt vmcnt(24)
    buffer_load_dwordx4 v7, s[40:43], s79 offen offset:2048 nt lds
    s_waitcnt vmcnt(24)
    buffer_load_dwordx4 v7, s[40:43], s79 offen offset:3072 nt lds
    s_waitcnt vmcnt(24)
    s_mov_b32 m0, 155648
    s_add_u32 s79, s76, 69632
    s_cmp_ge_u32 s79, s77
    s_cselect_b32 s78, s77, 0
    s_sub_u32 s79, s79, s78
    buffer_load_dwordx4 v6, s[40:43], s79 offen offset:0 nt lds
    s_waitcnt vmcnt(24)
    buffer_load_dwordx4 v6, s[40:43], s79 offen offset:1024 nt lds
    s_waitcnt vmcnt(24)
    buffer_load_dwordx4 v7, s[40:43], s79 offen offset:2048 nt lds
    s_waitcnt vmcnt(24)
    buffer_load_dwordx4 v7, s[40:43], s79 offen offset:3072 nt lds
    s_waitcnt vmcnt(24)
    v_mov_b32 v11, 120
    s_mov_b64 exec, 1
    ds_write_b32 v4, v11 offset:0
    s_mov_b64 exec, -1
    s_cmp_eq_u32 s84, 0
    s_cbranch_scc1 LloadF
    s_and_b32 s80, s4, 1
    s_mul_i32 s80, s80, 3
    s_add_u32 s80, s80, s5
    s_sub_u32 s80, s80, 9
    s_lshl_b32 s81, s80, 4
    s_add_u32 s81, s81, 96
    v_and_b32 v13, 15, v1
    v_add_u32 v12, s81, v13
    v_mul_u32_u24 v12, 9216, v12
    v_and_b32 v13, 16, v1
    v_lshl_add_u32 v12, v13, 6, v12
    s_mul_i32 s81, s87, 9
    s_lshr_b32 s72, s64, 7
    s_add_u32 s72, s72, s81
    s_sub_u32 s72, 3, s72
    s_and_b32 s72, s72, 7
    s_cselect_b32 s73, 0xffff, -1
    s_add_u32 s72, s72, s81
    s_lshl_b32 s72, s72, 7
    s_lshr_b32 s74, s68, 7
    s_add_u32 s74, s74, s81
    s_sub_u32 s74, 3, s74
    s_and_b32 s74, s74, 7
    s_cselect_b32 s75, 0xffff, -1
    s_add_u32 s74, s74, s81
    s_lshl_b32 s74, s74, 7
    s_mov_b32 exec_lo, s73
    s_mov_b32 exec_hi, 0
    buffer_load_dword v15, v12, s[64:67], s72 offen
    s_mov_b64 exec, -1
    s_add_u32 s72, s72, 737280
    s_waitcnt vmcnt(12)
    v_mov_b32 v11, 128
    s_mov_b64 exec, 1
    ds_write_b32 v4, v11 offset:0
    s_mov_b64 exec, -1
    s_mov_b32 exec_lo, s75
    s_mov_b32 exec_hi, 0
    buffer_load_dword v15, v12, s[68:71], s74 offen
    s_mov_b64 exec, -1
    s_add_u32 s74, s74, 737280
    s_waitcnt vmcnt(8)
    v_mov_b32 v11, 136
    s_mov_b64 exec, 1
    ds_write_b32 v4, v11 offset:0
    s_mov_b64 exec, -1
    s_mov_b32 exec_lo, s73
    s_mov_b32 exec_hi, 0
    buffer_load_dword v15, v12, s[64:67], s72 offen
    s_mov_b64 exec, -1
    s_add_u32 s72, s72, 737280
    s_waitcnt vmcnt(4)
    s_mov_b32 exec_lo, s75
    s_mov_b32 exec_hi, 0
    buffer_load_dword v15, v12, s[68:71], s74 offen
    s_mov_b64 exec, -1
    s_add_u32 s74, s74, 737280
    s_waitcnt vmcnt(3)
    v_mov_b32 v11, 144
    s_mov_b64 exec, 1
    ds_write_b32 v4, v11 offset:0
    s_mov_b64 exec, -1
    s_mov_b32 exec_lo, s73
    s_mov_b32 exec_hi, 0
    buffer_load_dword v15, v12, s[64:67], s72 offen
    s_mov_b64 exec, -1
    s_add_u32 s72, s72, 737280
    s_waitcnt vmcnt(3)
    s_mov_b32 exec_lo, s75
    s_mov_b32 exec_hi, 0
    buffer_load_dword v15, v12, s[68:71], s74 offen
    s_mov_b64 exec, -1
    s_add_u32 s74, s74, 737280
    s_waitcnt vmcnt(3)
    s_mov_b32 exec_lo, s73
    s_mov_b32 exec_hi, 0
    buffer_load_dword v15, v12, s[64:67], s72 offen
    s_mov_b64 exec, -1
    s_add_u32 s72, s72, 737280
    s_waitcnt vmcnt(3)
    s_mov_b32 exec_lo, s75
    s_mov_b32 exec_hi, 0
    buffer_load_dword v15, v12, s[68:71], s74 offen
    s_mov_b64 exec, -1
    s_add_u32 s74, s74, 737280
    s_waitcnt vmcnt(3)
    s_mov_b32 exec_lo, s73
    s_mov_b32 exec_hi, 0
    buffer_load_dword v15, v12, s[64:67], s72 offen
    s_mov_b64 exec, -1
    s_add_u32 s72, s72, 737280
    s_waitcnt vmcnt(3)
    s_mov_b32 exec_lo, s75
    s_mov_b32 exec_hi, 0
    buffer_load_dword v15, v12, s[68:71], s74 offen
    s_mov_b64 exec, -1
    s_add_u32 s74, s74, 737280
    s_waitcnt vmcnt(3)
    s_mov_b32 exec_lo, s73
    s_mov_b32 exec_hi, 0
    buffer_load_dword v15, v12, s[64:67], s72 offen
    s_mov_b64 exec, -1
    s_add_u32 s72, s72, 737280
    s_waitcnt vmcnt(3)
    s_mov_b32 exec_lo, s75
    s_mov_b32 exec_hi, 0
    buffer_load_dword v15, v12, s[68:71], s74 offen
    s_mov_b64 exec, -1
    s_add_u32 s74, s74, 737280
    s_waitcnt vmcnt(3)
    s_mul_i32 s81, s87, 663552
    v_lshl_add_u32 v12, v1, 7, s81
    s_mul_i32 s79, s80, 36864
    s_add_u32 s79, s79, 32768
    s_mov_b32 s81, 663552
Lw_151:
    ds_read_b32 v16, v4 offset:24
    s_waitcnt lgkmcnt(0)
    v_readfirstlane_b32 s78, v16
    s_cmp_ge_u32 s78, 8
    s_cbranch_scc1 Lwk_152
    s_sleep 1
    s_sub_u32 s0, s0, 1
    s_cbranch_scc0 Lw_151
    s_endpgm
Lwk_152:
    s_mov_b32 exec_hi, 0
    buffer_load_dword v15, v12, s[52:55], s79 offen
    s_mov_b64 exec, -1
    s_add_u32 s79, s79, 184320
    s_cmp_ge_u32 s79, s81
    s_cselect_b32 s78, 667648, 0
    s_sub_u32 s79, s79, s78
    s_waitcnt vmcnt(6)
    s_mov_b32 exec_hi, 0
    buffer_load_dword v15, v12, s[52:55], s79 offen
    s_mov_b64 exec, -1
    s_add_u32 s79, s79, 184320
    s_cmp_ge_u32 s79, s81
    s_cselect_b32 s78, 667648, 0
    s_sub_u32 s79, s79, s78
    s_waitcnt vmcnt(6)
    s_mov_b32 exec_hi, 0
    buffer_load_dword v15, v12, s[52:55], s79 offen
    s_mov_b64 exec, -1
    s_add_u32 s79, s79, 184320
    s_cmp_ge_u32 s79, s81
    s_cselect_b32 s78, 667648, 0
    s_sub_u32 s79, s79, s78
    s_waitcnt vmcnt(7)
    s_mov_b32 exec_hi, 0
    buffer_load_dword v15, v12, s[52:55], s79 offen
    s_mov_b64 exec, -1
    s_add_u32 s79, s79, 184320
    s_cmp_ge_u32 s79, s81
    s_cselect_b32 s78, 667648, 0
    s_sub_u32 s79, s79, s78
    s_waitcnt vmcnt(7)
    s_mov_b32 exec_hi, 0
    buffer_load_dword v15, v12, s[52:55], s79 offen
    s_mov_b64 exec, -1
    s_add_u32 s79, s79, 184320
    s_cmp_ge_u32 s79, s81
    s_cselect_b32 s78, 667648, 0
    s_sub_u32 s79, s79, s78
    s_waitcnt vmcnt(7)
    s_mov_b32 exec_hi, 0
    buffer_load_dword v15, v12, s[52:55], s79 offen
    s_mov_b64 exec, -1
    s_add_u32 s79, s79, 184320
    s_cmp_ge_u32 s79, s81
    s_cselect_b32 s78, 667648, 0
    s_sub_u32 s79, s79, s78
    s_waitcnt vmcnt(7)
    s_mov_b32 exec_hi, 0
    buffer_load_dword v15, v12, s[52:55], s79 offen
    s_mov_b64 exec, -1
    s_add_u32 s79, s79, 184320
    s_cmp_ge_u32 s79, s81
    s_cselect_b32 s78, 667648, 0
    s_sub_u32 s79, s79, s78
    s_waitcnt vmcnt(7)
    s_mov_b32 exec_hi, 0
    buffer_load_dword v15, v12, s[52:55], s79 offen
    s_mov_b64 exec, -1
    s_add_u32 s79, s79, 184320
    s_cmp_ge_u32 s79, s81
    s_cselect_b32 s78, 667648, 0
    s_sub_u32 s79, s79, s78
    s_waitcnt vmcnt(8)
    s_mov_b32 exec_hi, 0
    buffer_load_dword v15, v12, s[52:55], s79 offen
    s_mov_b64 exec, -1
    s_add_u32 s79, s79, 184320
    s_cmp_ge_u32 s79, s81
    s_cselect_b32 s78, 667648, 0
    s_sub_u32 s79, s79, s78
    s_waitcnt vmcnt(8)
    s_mov_b32 exec_hi, 0
    buffer_load_dword v15, v12, s[52:55], s79 offen
    s_mov_b64 exec, -1
    s_add_u32 s79, s79, 184320
    s_cmp_ge_u32 s79, s81
    s_cselect_b32 s78, 667648, 0
    s_sub_u32 s79, s79, s78
    s_waitcnt vmcnt(8)
    s_mov_b32 exec_hi, 0
    buffer_load_dword v15, v12, s[52:55], s79 offen
    s_mov_b64 exec, -1
    s_add_u32 s79, s79, 184320
    s_cmp_ge_u32 s79, s81
    s_cselect_b32 s78, 667648, 0
    s_sub_u32 s79, s79, s78
    s_waitcnt vmcnt(8)
    s_mov_b32 exec_hi, 0
    buffer_load_dword v15, v12, s[52:55], s79 offen
    s_mov_b64 exec, -1
    s_add_u32 s79, s79, 184320
    s_cmp_ge_u32 s79, s81
    s_cselect_b32 s78, 667648, 0
    s_sub_u32 s79, s79, s78
    s_waitcnt vmcnt(8)
    s_mov_b32 exec_hi, 0
    buffer_load_dword v15, v12, s[52:55], s79 offen
    s_mov_b64 exec, -1
    s_add_u32 s79, s79, 184320
    s_cmp_ge_u32 s79, s81
    s_cselect_b32 s78, 667648, 0
    s_sub_u32 s79, s79, s78
    s_waitcnt vmcnt(8)
    s_mov_b32 exec_hi, 0
    buffer_load_dword v15, v12, s[52:55], s79 offen
    s_mov_b64 exec, -1
    s_add_u32 s79, s79, 184320
    s_cmp_ge_u32 s79, s81
    s_cselect_b32 s78, 667648, 0
    s_sub_u32 s79, s79, s78
    s_waitcnt vmcnt(8)
    s_mov_b32 exec_hi, 0
    buffer_load_dword v15, v12, s[52:55], s79 offen
    s_mov_b64 exec, -1
    s_add_u32 s79, s79, 184320
    s_cmp_ge_u32 s79, s81
    s_cselect_b32 s78, 667648, 0
    s_sub_u32 s79, s79, s78
    s_waitcnt vmcnt(8)
    s_mov_b32 exec_hi, 0
    buffer_load_dword v15, v12, s[52:55], s79 offen
    s_mov_b64 exec, -1
    s_add_u32 s79, s79, 184320
    s_cmp_ge_u32 s79, s81
    s_cselect_b32 s78, 667648, 0
    s_sub_u32 s79, s79, s78
    s_waitcnt vmcnt(8)
    s_mov_b32 exec_hi, 0
    buffer_load_dword v15, v12, s[52:55], s79 offen
    s_mov_b64 exec, -1
    s_add_u32 s79, s79, 184320
    s_cmp_ge_u32 s79, s81
    s_cselect_b32 s78, 667648, 0
    s_sub_u32 s79, s79, s78
    s_waitcnt vmcnt(8)
    s_mov_b32 exec_hi, 0
    buffer_load_dword v15, v12, s[52:55], s79 offen
    s_mov_b64 exec, -1
    s_add_u32 s79, s79, 184320
    s_cmp_ge_u32 s79, s81
    s_cselect_b32 s78, 667648, 0
    s_sub_u32 s79, s79, s78
    s_waitcnt vmcnt(8)
    s_mov_b32 exec_hi, 0
    buffer_load_dword v15, v12, s[52:55], s79 offen
    s_mov_b64 exec, -1
    s_add_u32 s79, s79, 184320
    s_cmp_ge_u32 s79, s81
    s_cselect_b32 s78, 667648, 0
    s_sub_u32 s79, s79, s78
    s_waitcnt vmcnt(8)
    s_mov_b32 exec_hi, 0
    buffer_load_dword v15, v12, s[52:55], s79 offen
    s_mov_b64 exec, -1
    s_add_u32 s79, s79, 184320
    s_cmp_ge_u32 s79, s81
    s_cselect_b32 s78, 667648, 0
    s_sub_u32 s79, s79, s78
    s_waitcnt vmcnt(8)
    s_mov_b32 exec_hi, 0
    buffer_load_dword v15, v12, s[52:55], s79 offen
    s_mov_b64 exec, -1
    s_add_u32 s79, s79, 184320
    s_cmp_ge_u32 s79, s81
    s_cselect_b32 s78, 667648, 0
    s_sub_u32 s79, s79, s78
    s_waitcnt vmcnt(8)
    s_mov_b32 exec_hi, 0
    buffer_load_dword v15, v12, s[52:55], s79 offen
    s_mov_b64 exec, -1
    s_add_u32 s79, s79, 184320
    s_cmp_ge_u32 s79, s81
    s_cselect_b32 s78, 667648, 0
    s_sub_u32 s79, s79, s78
    s_waitcnt vmcnt(8)
    s_mov_b32 exec_hi, 0
    buffer_load_dword v15, v12, s[52:55], s79 offen
    s_mov_b64 exec, -1
    s_add_u32 s79, s79, 184320
    s_cmp_ge_u32 s79, s81
    s_cselect_b32 s78, 667648, 0
    s_sub_u32 s79, s79, s78
    s_waitcnt vmcnt(8)
    s_mov_b32 exec_hi, 0
    buffer_load_dword v15, v12, s[52:55], s79 offen
    s_mov_b64 exec, -1
    s_add_u32 s79, s79, 184320
    s_cmp_ge_u32 s79, s81
    s_cselect_b32 s78, 667648, 0
    s_sub_u32 s79, s79, s78
    s_waitcnt vmcnt(8)
    v_mov_b32 v16, 9
    s_mov_b64 exec, 1
    ds_write_b32 v4, v16 offset:40
    s_mov_b64 exec, -1
    s_branch Lfin
LloadF:
    v_lshrrev_b32 v12, 2, v1
    v_mul_u32_u24 v12, 9216, v12
    v_lshrrev_b32 v13, 5, v1
    v_xor_b32 v13, v13, v14
    s_lshl_b32 s80, s82, 6
    v_lshl_add_u32 v8, v13, 4, s80
    v_add_u32 v8, v8, v12
    v_xor_b32 v9, 32, v8
    s_mul_i32 s80, s82, 36864
    v_mul_u32_u24 v12, 1152, v2
    v_and_b32 v13, 2, v2
    v_xor_b32 v13, v13, v3
    v_lshl_add_u32 v10, v13, 4, s80
    v_add_u32 v10, v10, v12
    v_xor_b32 v5, 64, v10
    s_and_b32 s80, s82, 1
    s_mul_i32 s81, s80, 294912
Lw_153:
    ds_read_b32 v16, v4 offset:20
    s_waitcnt lgkmcnt(0)
    v_readfirstlane_b32 s78, v16
    s_cmp_ge_u32 s78, s83
    s_cbranch_scc1 Lwk_154
    s_sleep 1
    s_sub_u32 s0, s0, 1
    s_cbranch_scc0 Lw_153
    s_endpgm
Lwk_154:
    s_add_u32 s79, 0, s81
    s_mov_b32 m0, 12288
    s_nop 0
    buffer_load_dwordx4 v8, s[64:67], s79 offen  lds
    s_waitcnt vmcnt(23)
    s_mov_b32 m0, 49152
    s_nop 0
    buffer_load_dwordx4 v9, s[68:71], s79 offen  lds
    s_waitcnt vmcnt(22)
    s_add_u32 s79, 147456, s81
    s_mov_b32 m0, 13312
    s_nop 0
    buffer_load_dwordx4 v8, s[64:67], s79 offen  lds
    s_waitcnt vmcnt(21)
    s_mov_b32 m0, 50176
    s_nop 0
    buffer_load_dwordx4 v9, s[68:71], s79 offen  lds
    s_waitcnt vmcnt(20)
    v_mov_b32 v11, 128
    s_mov_b64 exec, 1
    ds_write_b32 v4, v11 offset:0
    s_mov_b64 exec, -1
    s_add_u32 s79, 589824, s81
    s_mov_b32 m0, 16384
    s_nop 0
    buffer_load_dwordx4 v8, s[64:67], s79 offen  lds
    s_waitcnt vmcnt(19)
    s_mov_b32 m0, 53248
    s_nop 0
    buffer_load_dwordx4 v9, s[68:71], s79 offen  lds
    s_waitcnt vmcnt(18)
    s_add_u32 s79, 737280, s81
    s_mov_b32 m0, 17408
    s_nop 0
    buffer_load_dwordx4 v8, s[64:67], s79 offen  lds
    s_waitcnt vmcnt(17)
    s_mov_b32 m0, 54272
    s_nop 0
    buffer_load_dwordx4 v9, s[68:71], s79 offen  lds
    s_waitcnt vmcnt(16)
    v_mov_b32 v11, 136
    s_mov_b64 exec, 1
    ds_write_b32 v4, v11 offset:0
    s_mov_b64 exec, -1
    s_add_u32 s79, 1179648, s81
    s_mov_b32 m0, 20480
    s_nop 0
    buffer_load_dwordx4 v8, s[64:67], s79 offen  lds
    s_waitcnt vmcnt(15)
    s_mov_b32 m0, 57344
    s_nop 0
    buffer_load_dwordx4 v9, s[68:71], s79 offen  lds
    s_waitcnt vmcnt(14)
    s_add_u32 s79, 1327104, s81
    s_mov_b32 m0, 21504
    s_nop 0
    buffer_load_dwordx4 v8, s[64:67], s79 offen  lds
    s_waitcnt vmcnt(13)
    s_mov_b32 m0, 58368
    s_nop 0
    buffer_load_dwordx4 v9, s[68:71], s79 offen  lds
    s_waitcnt vmcnt(12)
    v_mov_b32 v11, 144
    s_mov_b64 exec, 1
    ds_write_b32 v4, v11 offset:0
    s_mov_b64 exec, -1
    s_add_u32 s79, 1769472, s81
    s_mov_b32 m0, 24576
    s_nop 0
    buffer_load_dwordx4 v8, s[64:67], s79 offen  lds
    s_waitcnt vmcnt(12)
    s_mov_b32 m0, 61440
    s_nop 0
    buffer_load_dwordx4 v9, s[68:71], s79 offen  lds
    s_waitcnt vmcnt(12)
    s_add_u32 s79, 1916928, s81
    s_mov_b32 m0, 25600
    s_nop 0
    buffer_load_dwordx4 v8, s[64:67], s79 offen  lds
    s_waitcnt vmcnt(12)
    s_mov_b32 m0, 62464
    s_nop 0
    buffer_load_dwordx4 v9, s[68:71], s79 offen  lds
    s_waitcnt vmcnt(12)
    s_add_u32 s79, 2359296, s81
    s_mov_b32 m0, 28672
    s_nop 0
    buffer_load_dwordx4 v8, s[64:67], s79 offen  lds
    s_waitcnt vmcnt(12)
    s_mov_b32 m0, 65536
    s_nop 0
    buffer_load_dwordx4 v9, s[68:71], s79 offen  lds
    s_waitcnt vmcnt(12)
    s_add_u32 s79, 2506752, s81
    s_mov_b32 m0, 29696
    s_nop 0
    buffer_load_dwordx4 v8, s[64:67], s79 offen  lds
    s_waitcnt vmcnt(12)
    s_mov_b32 m0, 66560
    s_nop 0
    buffer_load_dwordx4 v9, s[68:71], s79 offen  lds
    s_waitcnt vmcnt(12)
    v_mov_b32 v11, 152
    s_mov_b64 exec, 1
    ds_write_b32 v4, v11 offset:0
    s_mov_b64 exec, -1
    s_add_u32 s79, 2949120, s81
    s_mov_b32 m0, 32768
    s_nop 0
    buffer_load_dwordx4 v8, s[64:67], s79 offen  lds
    s_waitcnt vmcnt(16)
    s_mov_b32 m0, 69632
    s_nop 0
    buffer_load_dwordx4 v9, s[68:71], s79 offen  lds
    s_waitcnt vmcnt(16)
    s_add_u32 s79, 3096576, s81
    s_mov_b32 m0, 33792
    s_nop 0
    buffer_load_dwordx4 v8, s[64:67], s79 offen  lds
    s_waitcnt vmcnt(16)
    s_mov_b32 m0, 70656
    s_nop 0
    buffer_load_dwordx4 v9, s[68:71], s79 offen  lds
    s_waitcnt vmcnt(16)
    s_add_u32 s79, 3538944, s81
    s_mov_b32 m0, 36864
    s_nop 0
    buffer_load_dwordx4 v8, s[64:67], s79 offen  lds
    s_waitcnt vmcnt(16)
    s_mov_b32 m0, 73728
    s_nop 0
    buffer_load_dwordx4 v9, s[68:71], s79 offen  lds
    s_waitcnt vmcnt(16)
    s_add_u32 s79, 3686400, s81
    s_mov_b32 m0, 37888
    s_nop 0
    buffer_load_dwordx4 v8, s[64:67], s79 offen  lds
    s_waitcnt vmcnt(16)
    s_mov_b32 m0, 74752
    s_nop 0
    buffer_load_dwordx4 v9, s[68:71], s79 offen  lds
    s_waitcnt vmcnt(16)
    s_add_u32 s79, 4128768, s81
    s_mov_b32 m0, 40960
    s_nop 0
    buffer_load_dwordx4 v8, s[64:67], s79 offen  lds
    s_waitcnt vmcnt(16)
    s_mov_b32 m0, 77824
    s_nop 0
    buffer_load_dwordx4 v9, s[68:71], s79 offen  lds
    s_waitcnt vmcnt(16)
    s_add_u32 s79, 4276224, s81
    s_mov_b32 m0, 41984
    s_nop 0
    buffer_load_dwordx4 v8, s[64:67], s79 offen  lds
    s_waitcnt vmcnt(16)
    s_mov_b32 m0, 78848
    s_nop 0
    buffer_load_dwordx4 v9, s[68:71], s79 offen  lds
    s_waitcnt vmcnt(16)
    v_mov_b32 v11, 160
    s_mov_b64 exec, 1
    ds_write_b32 v4, v11 offset:0
    s_mov_b64 exec, -1
    s_add_u32 s79, 4718592, s81
    s_mov_b32 m0, 45056
    s_nop 0
    buffer_load_dwordx4 v8, s[64:67], s79 offen  lds
    s_waitcnt vmcnt(16)
    s_mov_b32 m0, 81920
    s_nop 0
    buffer_load_dwordx4 v9, s[68:71], s79 offen  lds
    s_waitcnt vmcnt(16)
    s_add_u32 s79, 4866048, s81
    s_mov_b32 m0, 46080
    s_nop 0
    buffer_load_dwordx4 v8, s[64:67], s79 offen  lds
    s_waitcnt vmcnt(16)
    s_mov_b32 m0, 82944
    s_nop 0
    buffer_load_dwordx4 v9, s[68:71], s79 offen  lds
    s_waitcnt vmcnt(16)
Lw_155:
    ds_read_b32 v16, v4 offset:24
    s_waitcnt lgkmcnt(0)
    v_readfirstlane_b32 s78, v16
    s_cmp_ge_u32 s78, 8
    s_cbranch_scc1 Lwk_156
    s_sleep 1
    s_sub_u32 s0, s0, 1
    s_cbranch_scc0 Lw_155
    s_endpgm
Lwk_156:
    s_mov_b32 m0, 86016
    s_movk_i32 s92, 0
    buffer_load_dwordx4 v10, s[52:55], s92 offen nt lds
    s_waitcnt vmcnt(16)
    s_mov_b32 m0, 90112
    s_movk_i32 s92, 128
    buffer_load_dwordx4 v10, s[52:55], s92 offen nt lds
    s_waitcnt vmcnt(17)
    s_mov_b32 m0, 94208
    s_movk_i32 s92, 256
    buffer_load_dwordx4 v10, s[52:55], s92 offen nt lds
    s_waitcnt vmcnt(17)
    s_mov_b32 m0, 98304
    s_movk_i32 s92, 384
    buffer_load_dwordx4 v10, s[52:55], s92 offen nt lds
    s_waitcnt vmcnt(18)
    s_mov_b32 m0, 102400
    s_movk_i32 s92, 512
    buffer_load_dwordx4 v10, s[52:55], s92 offen nt lds
    s_waitcnt vmcnt(18)
    s_mov_b32 m0, 106496
    s_movk_i32 s92, 640
    buffer_load_dwordx4 v10, s[52:55], s92 offen nt lds
    s_waitcnt vmcnt(19)
    s_mov_b32 m0, 110592
    s_movk_i32 s92, 768
    buffer_load_dwordx4 v10, s[52:55], s92 offen nt lds
    s_waitcnt vmcnt(19)
    v_mov_b32 v11, 168
    s_mov_b64 exec, 1
    ds_write_b32 v4, v11 offset:0
    s_mov_b64 exec, -1
    s_mov_b32 m0, 114688
    s_movk_i32 s92, 896
    buffer_load_dwordx4 v10, s[52:55], s92 offen nt lds
    s_waitcnt vmcnt(20)
    s_mov_b32 m0, 118784
    s_movk_i32 s92, 1024
    buffer_load_dwordx4 v10, s[52:55], s92 offen nt lds
    s_waitcnt vmcnt(20)
    s_mov_b32 m0, 87040
    s_movk_i32 s92, 9216
    buffer_load_dwordx4 v5, s[52:55], s92 offen nt lds
    s_waitcnt vmcnt(21)
    s_mov_b32 m0, 91136
    s_movk_i32 s92, 9344
    buffer_load_dwordx4 v5, s[52:55], s92 offen nt lds
    s_waitcnt vmcnt(21)
    s_mov_b32 m0, 95232
    s_movk_i32 s92, 9472
    buffer_load_dwordx4 v5, s[52:55], s92 offen nt lds
    s_waitcnt vmcnt(22)
    s_mov_b32 m0, 99328
    s_movk_i32 s92, 9600
    buffer_load_dwordx4 v5, s[52:55], s92 offen nt lds
    s_waitcnt vmcnt(22)
    s_mov_b32 m0, 103424
    s_movk_i32 s92, 9728
    buffer_load_dwordx4 v5, s[52:55], s92 offen nt lds
    s_waitcnt vmcnt(23)
    s_mov_b32 m0, 107520
    s_movk_i32 s92, 9856
    buffer_load_dwordx4 v5, s[52:55], s92 offen nt lds
    s_waitcnt vmcnt(23)
    s_mov_b32 m0, 111616
    s_movk_i32 s92, 9984
    buffer_load_dwordx4 v5, s[52:55], s92 offen nt lds
    s_waitcnt vmcnt(24)
    s_mov_b32 m0, 115712
    s_movk_i32 s92, 10112
    buffer_load_dwordx4 v5, s[52:55], s92 offen nt lds
    s_waitcnt vmcnt(24)
    s_mov_b32 m0, 119808
    s_movk_i32 s92, 10240
    buffer_load_dwordx4 v5, s[52:55], s92 offen nt lds
    s_waitcnt vmcnt(25)
    s_mov_b32 m0, 88064
    s_movk_i32 s92, 18432
    buffer_load_dwordx4 v10, s[52:55], s92 offen nt lds
    s_waitcnt vmcnt(25)
    s_mov_b32 m0, 92160
    s_movk_i32 s92, 18560
    buffer_load_dwordx4 v10, s[52:55], s92 offen nt lds
    s_waitcnt vmcnt(26)
    s_mov_b32 m0, 96256
    s_movk_i32 s92, 18688
    buffer_load_dwordx4 v10, s[52:55], s92 offen nt lds
    s_waitcnt vmcnt(26)
    s_mov_b32 m0, 100352
    s_movk_i32 s92, 18816
    buffer_load_dwordx4 v10, s[52:55], s92 offen nt lds
    s_waitcnt vmcnt(27)
    s_mov_b32 m0, 104448
    s_movk_i32 s92, 18944
    buffer_load_dwordx4 v10, s[52:55], s92 offen nt lds
    s_waitcnt vmcnt(27)
    v_mov_b32 v11, 176
    s_mov_b64 exec, 1
    ds_write_b32 v4, v11 offset:0
    s_mov_b64 exec, -1
    s_mov_b32 m0, 108544
    s_movk_i32 s92, 19072
    buffer_load_dwordx4 v10, s[52:55], s92 offen nt lds
    s_waitcnt vmcnt(28)
    s_mov_b32 m0, 112640
    s_movk_i32 s92, 19200
    buffer_load_dwordx4 v10, s[52:55], s92 offen nt lds
    s_waitcnt vmcnt(28)
    s_mov_b32 m0, 116736
    s_movk_i32 s92, 19328
    buffer_load_dwordx4 v10, s[52:55], s92 offen nt lds
    s_waitcnt vmcnt(29)
    s_mov_b32 m0, 120832
    s_movk_i32 s92, 19456
    buffer_load_dwordx4 v10, s[52:55], s92 offen nt lds
    s_waitcnt vmcnt(29)
    s_mov_b32 m0, 89088
    s_movk_i32 s92, 27648
    buffer_load_dwordx4 v5, s[52:55], s92 offen nt lds
    s_waitcnt vmcnt(30)
    s_mov_b32 m0, 93184
    s_movk_i32 s92, 27776
    buffer_load_dwordx4 v5, s[52:55], s92 offen nt lds
    s_waitcnt vmcnt(30)
    s_mov_b32 m0, 97280
    s_movk_i32 s92, 27904
    buffer_load_dwordx4 v5, s[52:55], s92 offen nt lds
    s_waitcnt vmcnt(31)
    s_mov_b32 m0, 101376
    s_movk_i32 s92, 28032
    buffer_load_dwordx4 v5, s[52:55], s92 offen nt lds
    s_waitcnt vmcnt(31)
    v_mov_b32 v11, 180
    s_mov_b64 exec, 1
    ds_write_b32 v4, v11 offset:0
    s_mov_b64 exec, -1
    s_mov_b32 m0, 105472
    s_movk_i32 s92, 28160
    buffer_load_dwordx4 v5, s[52:55], s92 offen nt lds
    s_waitcnt vmcnt(32)
    s_mov_b32 m0, 109568
    s_movk_i32 s92, 28288
    buffer_load_dwordx4 v5, s[52:55], s92 offen nt lds
    s_waitcnt vmcnt(32)
    s_mov_b32 m0, 113664
    s_movk_i32 s92, 28416
    buffer_load_dwordx4 v5, s[52:55], s92 offen nt lds
    s_waitcnt vmcnt(32)
    s_mov_b32 m0, 117760
    s_movk_i32 s92, 28544
    buffer_load_dwordx4 v5, s[52:55], s92 offen nt lds
    s_waitcnt vmcnt(32)
    s_mov_b32 m0, 121856
    s_movk_i32 s92, 28672
    buffer_load_dwordx4 v5, s[52:55], s92 offen nt lds
    s_waitcnt vmcnt(32)
    s_sub_u32 s79, 294912, s81
    s_mov_b32 m0, 14336
    s_nop 0
    buffer_load_dwordx4 v8, s[64:67], s79 offen  lds
    s_waitcnt vmcnt(31)
    s_mov_b32 m0, 51200
    s_nop 0
    buffer_load_dwordx4 v9, s[68:71], s79 offen  lds
    s_waitcnt vmcnt(30)
    s_sub_u32 s79, 442368, s81
    s_mov_b32 m0, 15360
    s_nop 0
    buffer_load_dwordx4 v8, s[64:67], s79 offen  lds
    s_waitcnt vmcnt(29)
    s_mov_b32 m0, 52224
    s_nop 0
    buffer_load_dwordx4 v9, s[68:71], s79 offen  lds
    s_waitcnt vmcnt(28)
    s_sub_u32 s79, 884736, s81
    s_mov_b32 m0, 18432
    s_nop 0
    buffer_load_dwordx4 v8, s[64:67], s79 offen  lds
    s_waitcnt vmcnt(27)
    s_mov_b32 m0, 55296
    s_nop 0
    buffer_load_dwordx4 v9, s[68:71], s79 offen  lds
    s_waitcnt vmcnt(26)
    s_sub_u32 s79, 1032192, s81
    s_mov_b32 m0, 19456
    s_nop 0
    buffer_load_dwordx4 v8, s[64:67], s79 offen  lds
    s_waitcnt vmcnt(25)
    s_mov_b32 m0, 56320
    s_nop 0
    buffer_load_dwordx4 v9, s[68:71], s79 offen  lds
    s_waitcnt vmcnt(24)
    s_sub_u32 s79, 1474560, s81
    s_mov_b32 m0, 22528
    s_nop 0
    buffer_load_dwordx4 v8, s[64:67], s79 offen  lds
    s_waitcnt vmcnt(23)
    s_mov_b32 m0, 59392
    s_nop 0
    buffer_load_dwordx4 v9, s[68:71], s79 offen  lds
    s_waitcnt vmcnt(22)
    s_sub_u32 s79, 1622016, s81
    s_mov_b32 m0, 23552
    s_nop 0
    buffer_load_dwordx4 v8, s[64:67], s79 offen  lds
    s_waitcnt vmcnt(21)
    s_mov_b32 m0, 60416
    s_nop 0
    buffer_load_dwordx4 v9, s[68:71], s79 offen  lds
    s_waitcnt vmcnt(20)
    s_sub_u32 s79, 2064384, s81
    s_mov_b32 m0, 26624
    s_nop 0
    buffer_load_dwordx4 v8, s[64:67], s79 offen  lds
    s_waitcnt vmcnt(19)
    s_mov_b32 m0, 63488
    s_nop 0
    buffer_load_dwordx4 v9, s[68:71], s79 offen  lds
    s_waitcnt vmcnt(18)
    s_sub_u32 s79, 2211840, s81
    s_mov_b32 m0, 27648
    s_nop 0
    buffer_load_dwordx4 v8, s[64:67], s79 offen  lds
    s_waitcnt vmcnt(17)
    s_mov_b32 m0, 64512
    s_nop 0
    buffer_load_dwordx4 v9, s[68:71], s79 offen  lds
    s_waitcnt vmcnt(16)
    v_mov_b32 v11, 216
    s_mov_b64 exec, 1
    ds_write_b32 v4, v11 offset:0
    s_mov_b64 exec, -1
    s_sub_u32 s79, 2654208, s81
    s_mov_b32 m0, 30720
    s_nop 0
    buffer_load_dwordx4 v8, s[64:67], s79 offen  lds
    s_waitcnt vmcnt(16)
    s_mov_b32 m0, 67584
    s_nop 0
    buffer_load_dwordx4 v9, s[68:71], s79 offen  lds
    s_waitcnt vmcnt(16)
    s_sub_u32 s79, 2801664, s81
    s_mov_b32 m0, 31744
    s_nop 0
    buffer_load_dwordx4 v8, s[64:67], s79 offen  lds
    s_waitcnt vmcnt(16)
    s_mov_b32 m0, 68608
    s_nop 0
    buffer_load_dwordx4 v9, s[68:71], s79 offen  lds
    s_waitcnt vmcnt(16)
    v_mov_b32 v11, 220
    s_mov_b64 exec, 1
    ds_write_b32 v4, v11 offset:0
    s_mov_b64 exec, -1
    s_sub_u32 s79, 3244032, s81
    s_mov_b32 m0, 34816
    s_nop 0
    buffer_load_dwordx4 v8, s[64:67], s79 offen  lds
    s_waitcnt vmcnt(16)
    s_mov_b32 m0, 71680
    s_nop 0
    buffer_load_dwordx4 v9, s[68:71], s79 offen  lds
    s_waitcnt vmcnt(16)
    s_sub_u32 s79, 3391488, s81
    s_mov_b32 m0, 35840
    s_nop 0
    buffer_load_dwordx4 v8, s[64:67], s79 offen  lds
    s_waitcnt vmcnt(16)
    s_mov_b32 m0, 72704
    s_nop 0
    buffer_load_dwordx4 v9, s[68:71], s79 offen  lds
    s_waitcnt vmcnt(16)
    s_sub_u32 s79, 3833856, s81
    s_mov_b32 m0, 38912
    s_nop 0
    buffer_load_dwordx4 v8, s[64:67], s79 offen  lds
    s_waitcnt vmcnt(16)
    s_mov_b32 m0, 75776
    s_nop 0
    buffer_load_dwordx4 v9, s[68:71], s79 offen  lds
    s_waitcnt vmcnt(16)
    s_sub_u32 s79, 3981312, s81
    s_mov_b32 m0, 39936
    s_nop 0
    buffer_load_dwordx4 v8, s[64:67], s79 offen  lds
    s_waitcnt vmcnt(16)
    s_mov_b32 m0, 76800
    s_nop 0
    buffer_load_dwordx4 v9, s[68:71], s79 offen  lds
    s_waitcnt vmcnt(16)
    v_mov_b32 v11, 228
    s_mov_b64 exec, 1
    ds_write_b32 v4, v11 offset:0
    s_mov_b64 exec, -1
    s_sub_u32 s79, 4423680, s81
    s_mov_b32 m0, 43008
    s_nop 0
    buffer_load_dwordx4 v8, s[64:67], s79 offen  lds
    s_waitcnt vmcnt(16)
    s_mov_b32 m0, 79872
    s_nop 0
    buffer_load_dwordx4 v9, s[68:71], s79 offen  lds
    s_waitcnt vmcnt(16)
    s_sub_u32 s79, 4571136, s81
    s_mov_b32 m0, 44032
    s_nop 0
    buffer_load_dwordx4 v8, s[64:67], s79 offen  lds
    s_waitcnt vmcnt(16)
    s_mov_b32 m0, 80896
    s_nop 0
    buffer_load_dwordx4 v9, s[68:71], s79 offen  lds
    s_waitcnt vmcnt(16)
    s_sub_u32 s79, 5013504, s81
    s_mov_b32 m0, 47104
    s_nop 0
    buffer_load_dwordx4 v8, s[64:67], s79 offen  lds
    s_waitcnt vmcnt(16)
    s_mov_b32 m0, 83968
    s_nop 0
    buffer_load_dwordx4 v9, s[68:71], s79 offen  lds
    s_waitcnt vmcnt(16)
    s_sub_u32 s79, 5160960, s81
    s_mov_b32 m0, 48128
    s_nop 0
    buffer_load_dwordx4 v8, s[64:67], s79 offen  lds
    s_waitcnt vmcnt(16)
    s_mov_b32 m0, 84992
    s_nop 0
    buffer_load_dwordx4 v9, s[68:71], s79 offen  lds
    s_waitcnt vmcnt(16)
    v_mov_b32 v11, 236
    s_mov_b64 exec, 1
    ds_write_b32 v4, v11 offset:0
    s_mov_b64 exec, -1
    s_waitcnt vmcnt(8)
    v_mov_b32 v11, 244
    s_mov_b64 exec, 1
    ds_write_b32 v4, v11 offset:0
    s_mov_b64 exec, -1
    s_waitcnt vmcnt(4)
    v_mov_b32 v11, 248
    s_mov_b64 exec, 1
    ds_write_b32 v4, v11 offset:0
    s_mov_b64 exec, -1
    s_waitcnt vmcnt(0)
    v_mov_b32 v11, 252
    s_mov_b64 exec, 1
    ds_write_b32 v4, v11 offset:0
    s_mov_b64 exec, -1
    s_branch Lfin
LloadW:
    s_mov_b32 m0, 32768
    s_add_u32 s79, s76, 20480
    s_cmp_ge_u32 s79, s77
    s_cselect_b32 s78, s77, 0
    s_sub_u32 s79, s79, s78
    buffer_load_dwordx4 v5, s[36:39], s79 offen offset:0 nt lds
    s_waitcnt vmcnt(20)
    buffer_load_dwordx4 v5, s[36:39], s79 offen offset:1024 nt lds
    s_waitcnt vmcnt(20)
    buffer_load_dwordx4 v5, s[36:39], s79 offen offset:2048 nt lds
    s_waitcnt vmcnt(20)
    buffer_load_dwordx4 v5, s[36:39], s79 offen offset:3072 nt lds
    s_waitcnt vmcnt(20)
    s_mov_b32 m0, 36864
    s_add_u32 s79, s76, 24576
    s_cmp_ge_u32 s79, s77
    s_cselect_b32 s78, s77, 0
    s_sub_u32 s79, s79, s78
    buffer_load_dwordx4 v5, s[36:39], s79 offen offset:0 nt lds
    s_waitcnt vmcnt(20)
    buffer_load_dwordx4 v5, s[36:39], s79 offen offset:1024 nt lds
    s_waitcnt vmcnt(20)
    buffer_load_dwordx4 v5, s[36:39], s79 offen offset:2048 nt lds
    s_waitcnt vmcnt(20)
    buffer_load_dwordx4 v5, s[36:39], s79 offen offset:3072 nt lds
    s_waitcnt vmcnt(20)
    v_mov_b32 v11, 8
    s_mov_b64 exec, 1
    ds_write_b32 v4, v11 offset:0
    s_mov_b64 exec, -1
    s_mov_b32 m0, 40960
    s_add_u32 s79, s76, 28672
    s_cmp_ge_u32 s79, s77
    s_cselect_b32 s78, s77, 0
    s_sub_u32 s79, s79, s78
    buffer_load_dwordx4 v5, s[36:39], s79 offen offset:0 nt lds
    s_waitcnt vmcnt(20)
    buffer_load_dwordx4 v5, s[36:39], s79 offen offset:1024 nt lds
    s_waitcnt vmcnt(20)
    buffer_load_dwordx4 v5, s[36:39], s79 offen offset:2048 nt lds
    s_waitcnt vmcnt(20)
    buffer_load_dwordx4 v5, s[36:39], s79 offen offset:3072 nt lds
    s_waitcnt vmcnt(20)
    s_mov_b32 m0, 45056
    s_add_u32 s79, s76, 32768
    s_cmp_ge_u32 s79, s77
    s_cselect_b32 s78, s77, 0
    s_sub_u32 s79, s79, s78
    buffer_load_dwordx4 v5, s[36:39], s79 offen offset:0 nt lds
    s_waitcnt vmcnt(20)
    buffer_load_dwordx4 v5, s[36:39], s79 offen offset:1024 nt lds
    s_waitcnt vmcnt(20)
    buffer_load_dwordx4 v5, s[36:39], s79 offen offset:2048 nt lds
    s_waitcnt vmcnt(20)
    buffer_load_dwordx4 v5, s[36:39], s79 offen offset:3072 nt lds
    s_waitcnt vmcnt(20)
    v_mov_b32 v11, 16
    s_mov_b64 exec, 1
    ds_write_b32 v4, v11 offset:0
    s_mov_b64 exec, -1
    s_mov_b32 m0, 49152
    s_add_u32 s79, s76, 36864
    s_cmp_ge_u32 s79, s77
    s_cselect_b32 s78, s77, 0
    s_sub_u32 s79, s79, s78
    buffer_load_dwordx4 v5, s[36:39], s79 offen offset:0 nt lds
    s_waitcnt vmcnt(20)
    buffer_load_dwordx4 v5, s[36:39], s79 offen offset:1024 nt lds
    s_waitcnt vmcnt(20)
    buffer_load_dwordx4 v5, s[36:39], s79 offen offset:2048 nt lds
    s_waitcnt vmcnt(20)
    buffer_load_dwordx4 v5, s[36:39], s79 offen offset:3072 nt lds
    s_waitcnt vmcnt(20)
    s_mov_b32 m0, 53248
    s_add_u32 s79, s76, 40960
    s_cmp_ge_u32 s79, s77
    s_cselect_b32 s78, s77, 0
    s_sub_u32 s79, s79, s78
    s_cmp_le_u32 s77, 40960
    s_cselect_b32 s79, s77, s79
    buffer_load_dwordx4 v5, s[36:39], s79 offen offset:0 nt lds
    s_waitcnt vmcnt(20)
    buffer_load_dwordx4 v5, s[36:39], s79 offen offset:1024 nt lds
    s_waitcnt vmcnt(20)
    buffer_load_dwordx4 v5, s[36:39], s79 offen offset:2048 nt lds
    s_waitcnt vmcnt(20)
    buffer_load_dwordx4 v5, s[36:39], s79 offen offset:3072 nt lds
    s_waitcnt vmcnt(20)
    v_mov_b32 v11, 24
    s_mov_b64 exec, 1
    ds_write_b32 v4, v11 offset:0
    s_mov_b64 exec, -1
    s_mov_b32 m0, 57344
    s_add_u32 s79, s76, 45056
    s_cmp_ge_u32 s79, s77
    s_cselect_b32 s78, s77, 0
    s_sub_u32 s79, s79, s78
    s_cmp_le_u32 s77, 45056
    s_cselect_b32 s79, s77, s79
    buffer_load_dwordx4 v5, s[36:39], s79 offen offset:0 nt lds
    s_waitcnt vmcnt(20)
    buffer_load_dwordx4 v5, s[36:39], s79 offen offset:1024 nt lds
    s_waitcnt vmcnt(20)
    buffer_load_dwordx4 v5, s[36:39], s79 offen offset:2048 nt lds
    s_waitcnt vmcnt(20)
    buffer_load_dwordx4 v5, s[36:39], s79 offen offset:3072 nt lds
    s_waitcnt vmcnt(20)
    s_mov_b32 m0, 86016
    s_add_u32 s79, s76, 0
    s_cmp_ge_u32 s79, s77
    s_cselect_b32 s78, s77, 0
    s_sub_u32 s79, s79, s78
    buffer_load_dwordx4 v6, s[40:43], s79 offen offset:0 nt lds
    s_waitcnt vmcnt(20)
    buffer_load_dwordx4 v6, s[40:43], s79 offen offset:1024 nt lds
    s_waitcnt vmcnt(20)
    buffer_load_dwordx4 v7, s[40:43], s79 offen offset:2048 nt lds
    s_waitcnt vmcnt(20)
    buffer_load_dwordx4 v7, s[40:43], s79 offen offset:3072 nt lds
    s_waitcnt vmcnt(20)
    v_mov_b32 v11, 32
    s_mov_b64 exec, 1
    ds_write_b32 v4, v11 offset:0
    s_mov_b64 exec, -1
    s_mov_b32 m0, 90112
    s_add_u32 s79, s76, 4096
    s_cmp_ge_u32 s79, s77
    s_cselect_b32 s78, s77, 0
    s_sub_u32 s79, s79, s78
    buffer_load_dwordx4 v6, s[40:43], s79 offen offset:0 nt lds
    s_waitcnt vmcnt(20)
    buffer_load_dwordx4 v6, s[40:43], s79 offen offset:1024 nt lds
    s_waitcnt vmcnt(20)
    buffer_load_dwordx4 v7, s[40:43], s79 offen offset:2048 nt lds
    s_waitcnt vmcnt(20)
    buffer_load_dwordx4 v7, s[40:43], s79 offen offset:3072 nt lds
    s_waitcnt vmcnt(20)
    s_mov_b32 m0, 94208
    s_add_u32 s79, s76, 8192
    s_cmp_ge_u32 s79, s77
    s_cselect_b32 s78, s77, 0
    s_sub_u32 s79, s79, s78
    buffer_load_dwordx4 v6, s[40:43], s79 offen offset:0 nt lds
    s_waitcnt vmcnt(20)
    buffer_load_dwordx4 v6, s[40:43], s79 offen offset:1024 nt lds
    s_waitcnt vmcnt(20)
    buffer_load_dwordx4 v7, s[40:43], s79 offen offset:2048 nt lds
    s_waitcnt vmcnt(20)
    buffer_load_dwordx4 v7, s[40:43], s79 offen offset:3072 nt lds
    s_waitcnt vmcnt(20)
    v_mov_b32 v11, 40
    s_mov_b64 exec, 1
    ds_write_b32 v4, v11 offset:0
    s_mov_b64 exec, -1
    s_mov_b32 m0, 98304
    s_add_u32 s79, s76, 12288
    s_cmp_ge_u32 s79, s77
    s_cselect_b32 s78, s77, 0
    s_sub_u32 s79, s79, s78
    buffer_load_dwordx4 v6, s[40:43], s79 offen offset:0 nt lds
    s_waitcnt vmcnt(20)
    buffer_load_dwordx4 v6, s[40:43], s79 offen offset:1024 nt lds
    s_waitcnt vmcnt(20)
    buffer_load_dwordx4 v7, s[40:43], s79 offen offset:2048 nt lds
    s_waitcnt vmcnt(20)
    buffer_load_dwordx4 v7, s[40:43], s79 offen offset:3072 nt lds
    s_waitcnt vmcnt(20)
    s_mov_b32 m0, 102400
    s_add_u32 s79, s76, 16384
    s_cmp_ge_u32 s79, s77
    s_cselect_b32 s78, s77, 0
    s_sub_u32 s79, s79, s78
    buffer_load_dwordx4 v6, s[40:43], s79 offen offset:0 nt lds
    s_waitcnt vmcnt(20)
    buffer_load_dwordx4 v6, s[40:43], s79 offen offset:1024 nt lds
    s_waitcnt vmcnt(20)
    buffer_load_dwordx4 v7, s[40:43], s79 offen offset:2048 nt lds
    s_waitcnt vmcnt(20)
    buffer_load_dwordx4 v7, s[40:43], s79 offen offset:3072 nt lds
    s_waitcnt vmcnt(20)
    v_mov_b32 v11, 48
    s_mov_b64 exec, 1
    ds_write_b32 v4, v11 offset:0
    s_mov_b64 exec, -1
    s_mov_b32 m0, 106496
    s_add_u32 s79, s76, 20480
    s_cmp_ge_u32 s79, s77
    s_cselect_b32 s78, s77, 0
    s_sub_u32 s79, s79, s78
    buffer_load_dwordx4 v6, s[40:43], s79 offen offset:0 nt lds
    s_waitcnt vmcnt(20)
    buffer_load_dwordx4 v6, s[40:43], s79 offen offset:1024 nt lds
    s_waitcnt vmcnt(20)
    buffer_load_dwordx4 v7, s[40:43], s79 offen offset:2048 nt lds
    s_waitcnt vmcnt(20)
    buffer_load_dwordx4 v7, s[40:43], s79 offen offset:3072 nt lds
    s_waitcnt vmcnt(20)
    s_mov_b32 m0, 110592
    s_add_u32 s79, s76, 24576
    s_cmp_ge_u32 s79, s77
    s_cselect_b32 s78, s77, 0
    s_sub_u32 s79, s79, s78
    buffer_load_dwordx4 v6, s[40:43], s79 offen offset:0 nt lds
    s_waitcnt vmcnt(20)
    buffer_load_dwordx4 v6, s[40:43], s79 offen offset:1024 nt lds
    s_waitcnt vmcnt(20)
    buffer_load_dwordx4 v7, s[40:43], s79 offen offset:2048 nt lds
    s_waitcnt vmcnt(20)
    buffer_load_dwordx4 v7, s[40:43], s79 offen offset:3072 nt lds
    s_waitcnt vmcnt(20)
    v_mov_b32 v11, 80
    s_mov_b64 exec, 1
    ds_write_b32 v4, v11 offset:0
    s_mov_b64 exec, -1
    s_mov_b32 m0, 114688
    s_add_u32 s79, s76, 28672
    s_cmp_ge_u32 s79, s77
    s_cselect_b32 s78, s77, 0
    s_sub_u32 s79, s79, s78
    buffer_load_dwordx4 v6, s[40:43], s79 offen offset:0 nt lds
    s_waitcnt vmcnt(20)
    buffer_load_dwordx4 v6, s[40:43], s79 offen offset:1024 nt lds
    s_waitcnt vmcnt(20)
    buffer_load_dwordx4 v7, s[40:43], s79 offen offset:2048 nt lds
    s_waitcnt vmcnt(20)
    buffer_load_dwordx4 v7, s[40:43], s79 offen offset:3072 nt lds
    s_waitcnt vmcnt(20)
    s_mov_b32 m0, 118784
    s_add_u32 s79, s76, 32768
    s_cmp_ge_u32 s79, s77
    s_cselect_b32 s78, s77, 0
    s_sub_u32 s79, s79, s78
    buffer_load_dwordx4 v6, s[40:43], s79 offen offset:0 nt lds
    s_waitcnt vmcnt(20)
    buffer_load_dwordx4 v6, s[40:43], s79 offen offset:1024 nt lds
    s_waitcnt vmcnt(20)
    buffer_load_dwordx4 v7, s[40:43], s79 offen offset:2048 nt lds
    s_waitcnt vmcnt(20)
    buffer_load_dwordx4 v7, s[40:43], s79 offen offset:3072 nt lds
    s_waitcnt vmcnt(20)
    v_mov_b32 v11, 88
    s_mov_b64 exec, 1
    ds_write_b32 v4, v11 offset:0
    s_mov_b64 exec, -1
    s_mov_b32 m0, 122880
    s_add_u32 s79, s76, 36864
    s_cmp_ge_u32 s79, s77
    s_cselect_b32 s78, s77, 0
    s_sub_u32 s79, s79, s78
    buffer_load_dwordx4 v6, s[40:43], s79 offen offset:0 nt lds
    s_waitcnt vmcnt(20)
    buffer_load_dwordx4 v6, s[40:43], s79 offen offset:1024 nt lds
    s_waitcnt vmcnt(20)
    buffer_load_dwordx4 v7, s[40:43], s79 offen offset:2048 nt lds
    s_waitcnt vmcnt(20)
    buffer_load_dwordx4 v7, s[40:43], s79 offen offset:3072 nt lds
    s_waitcnt vmcnt(20)
    s_mov_b32 m0, 126976
    s_add_u32 s79, s76, 40960
    s_cmp_ge_u32 s79, s77
    s_cselect_b32 s78, s77, 0
    s_sub_u32 s79, s79, s78
    s_cmp_le_u32 s77, 40960
    s_cselect_b32 s79, s77, s79
    buffer_load_dwordx4 v6, s[40:43], s79 offen offset:0 nt lds
    s_waitcnt vmcnt(20)
    buffer_load_dwordx4 v6, s[40:43], s79 offen offset:1024 nt lds
    s_waitcnt vmcnt(20)
    buffer_load_dwordx4 v7, s[40:43], s79 offen offset:2048 nt lds
    s_waitcnt vmcnt(20)
    buffer_load_dwordx4 v7, s[40:43], s79 offen offset:3072 nt lds
    s_waitcnt vmcnt(20)
    v_mov_b32 v11, 96
    s_mov_b64 exec, 1
    ds_write_b32 v4, v11 offset:0
    s_mov_b64 exec, -1
    s_mov_b32 m0, 131072
    s_add_u32 s79, s76, 45056
    s_cmp_ge_u32 s79, s77
    s_cselect_b32 s78, s77, 0
    s_sub_u32 s79, s79, s78
    s_cmp_le_u32 s77, 45056
    s_cselect_b32 s79, s77, s79
    buffer_load_dwordx4 v6, s[40:43], s79 offen offset:0 nt lds
    s_waitcnt vmcnt(20)
    buffer_load_dwordx4 v6, s[40:43], s79 offen offset:1024 nt lds
    s_waitcnt vmcnt(20)
    buffer_load_dwordx4 v7, s[40:43], s79 offen offset:2048 nt lds
    s_waitcnt vmcnt(20)
    buffer_load_dwordx4 v7, s[40:43], s79 offen offset:3072 nt lds
    s_waitcnt vmcnt(20)
    s_lshl_b32 s80, s87, 9
    v_add_u32 v12, s80, v2
    v_mul_u32_u24 v12, 1152, v12
    s_lshl_b32 s80, s86, 7
    v_lshl_add_u32 v8, v3, 4, s80
    v_add_u32 v8, v8, v12
Lw_157:
    ds_read_b32 v16, v4 offset:20
    s_waitcnt lgkmcnt(0)
    v_readfirstlane_b32 s78, v16
    s_cmp_ge_u32 s78, s83
    s_cbranch_scc1 Lwk_158
    s_sleep 1
    s_sub_u32 s0, s0, 1
    s_cbranch_scc0 Lw_157
    s_endpgm
Lwk_158:
    s_mov_b32 s79, 0
    s_mov_b32 m0, 12288
    s_nop 0
    buffer_load_dwordx4 v8, s[52:55], s79 offen nt lds
    s_waitcnt vmcnt(32)
    s_mov_b32 s79, 9216
    s_mov_b32 m0, 13312
    s_nop 0
    buffer_load_dwordx4 v8, s[52:55], s79 offen nt lds
    s_waitcnt vmcnt(32)
    s_mov_b32 s79, 18432
    s_mov_b32 m0, 14336
    s_nop 0
    buffer_load_dwordx4 v8, s[52:55], s79 offen nt lds
    s_waitcnt vmcnt(32)
    s_mov_b32 s79, 27648
    s_mov_b32 m0, 15360
    s_nop 0
    buffer_load_dwordx4 v8, s[52:55], s79 offen nt lds
    s_waitcnt vmcnt(32)
    s_mov_b32 s79, 36864
    s_mov_b32 m0, 16384
    s_nop 0
    buffer_load_dwordx4 v8, s[52:55], s79 offen nt lds
    s_waitcnt vmcnt(32)
    s_mov_b32 s79, 46080
    s_mov_b32 m0, 17408
    s_nop 0
    buffer_load_dwordx4 v8, s[52:55], s79 offen nt lds
    s_waitcnt vmcnt(32)
    s_mov_b32 s79, 55296
    s_mov_b32 m0, 18432
    s_nop 0
    buffer_load_dwordx4 v8, s[52:55], s79 offen nt lds
    s_waitcnt vmcnt(32)
    s_mov_b32 s79, 64512
    s_mov_b32 m0, 19456
    s_nop 0
    buffer_load_dwordx4 v8, s[52:55], s79 offen nt lds
    s_waitcnt vmcnt(32)
    s_mov_b32 s79, 73728
    s_mov_b32 m0, 20480
    s_nop 0
    buffer_load_dwordx4 v8, s[52:55], s79 offen nt lds
    s_waitcnt vmcnt(32)
    s_mov_b32 s79, 82944
    s_mov_b32 m0, 21504
    s_nop 0
    buffer_load_dwordx4 v8, s[52:55], s79 offen nt lds
    s_waitcnt vmcnt(32)
    s_mov_b32 s79, 92160
    s_mov_b32 m0, 22528
    s_nop 0
    buffer_load_dwordx4 v8, s[52:55], s79 offen nt lds
    s_waitcnt vmcnt(32)
    s_mov_b32 s79, 101376
    s_mov_b32 m0, 23552
    s_nop 0
    buffer_load_dwordx4 v8, s[52:55], s79 offen nt lds
    s_waitcnt vmcnt(32)
    s_mov_b32 s79, 110592
    s_mov_b32 m0, 24576
    s_nop 0
    buffer_load_dwordx4 v8, s[52:55], s79 offen nt lds
    s_waitcnt vmcnt(32)
    s_mov_b32 s79, 119808
    s_mov_b32 m0, 25600
    s_nop 0
    buffer_load_dwordx4 v8, s[52:55], s79 offen nt lds
    s_waitcnt vmcnt(32)
    s_mov_b32 s79, 129024
    s_mov_b32 m0, 26624
    s_nop 0
    buffer_load_dwordx4 v8, s[52:55], s79 offen nt lds
    s_waitcnt vmcnt(32)
    s_mov_b32 s79, 138240
    s_mov_b32 m0, 27648
    s_nop 0
    buffer_load_dwordx4 v8, s[52:55], s79 offen nt lds
    s_waitcnt vmcnt(32)
    v_mov_b32 v11, 104
    s_mov_b64 exec, 1
    ds_write_b32 v4, v11 offset:0
    s_mov_b64 exec, -1
    s_mov_b32 s79, 147456
    s_mov_b32 m0, 28672
    s_nop 0
    buffer_load_dwordx4 v8, s[52:55], s79 offen nt lds
    s_waitcnt vmcnt(32)
    s_mov_b32 s79, 156672
    s_mov_b32 m0, 29696
    s_nop 0
    buffer_load_dwordx4 v8, s[52:55], s79 offen nt lds
    s_waitcnt vmcnt(32)
    s_mov_b32 s79, 165888
    s_mov_b32 m0, 30720
    s_nop 0
    buffer_load_dwordx4 v8, s[52:55], s79 offen nt lds
    s_waitcnt vmcnt(32)
    s_mov_b32 s79, 175104
    s_mov_b32 m0, 31744
    s_nop 0
    buffer_load_dwordx4 v8, s[52:55], s79 offen nt lds
    s_waitcnt vmcnt(32)
    s_mov_b32 s79, 184320
    s_mov_b32 m0, 32768
    s_nop 0
    buffer_load_dwordx4 v8, s[52:55], s79 offen nt lds
    s_waitcnt vmcnt(32)
    s_mov_b32 s79, 193536
    s_mov_b32 m0, 33792
    s_nop 0
    buffer_load_dwordx4 v8, s[52:55], s79 offen nt lds
    s_waitcnt vmcnt(32)
    s_mov_b32 s79, 202752
    s_mov_b32 m0, 34816
    s_nop 0
    buffer_load_dwordx4 v8, s[52:55], s79 offen nt lds
    s_waitcnt vmcnt(32)
    s_mov_b32 s79, 211968
    s_mov_b32 m0, 35840
    s_nop 0
    buffer_load_dwordx4 v8, s[52:55], s79 offen nt lds
    s_waitcnt vmcnt(32)
    v_mov_b32 v11, 112
    s_mov_b64 exec, 1
    ds_write_b32 v4, v11 offset:0
    s_mov_b64 exec, -1
    s_mov_b32 s79, 221184
    s_mov_b32 m0, 36864
    s_nop 0
    buffer_load_dwordx4 v8, s[52:55], s79 offen nt lds
    s_waitcnt vmcnt(32)
    s_mov_b32 s79, 230400
    s_mov_b32 m0, 37888
    s_nop 0
    buffer_load_dwordx4 v8, s[52:55], s79 offen nt lds
    s_waitcnt vmcnt(32)
    s_mov_b32 s79, 239616
    s_mov_b32 m0, 38912
    s_nop 0
    buffer_load_dwordx4 v8, s[52:55], s79 offen nt lds
    s_waitcnt vmcnt(32)
    s_mov_b32 s79, 248832
    s_mov_b32 m0, 39936
    s_nop 0
    buffer_load_dwordx4 v8, s[52:55], s79 offen nt lds
    s_waitcnt vmcnt(32)
    s_mov_b32 s79, 258048
    s_mov_b32 m0, 40960
    s_nop 0
    buffer_load_dwordx4 v8, s[52:55], s79 offen nt lds
    s_waitcnt vmcnt(32)
    s_mov_b32 s79, 267264
    s_mov_b32 m0, 41984
    s_nop 0
    buffer_load_dwordx4 v8, s[52:55], s79 offen nt lds
    s_waitcnt vmcnt(32)
    s_mov_b32 s79, 276480
    s_mov_b32 m0, 43008
    s_nop 0
    buffer_load_dwordx4 v8, s[52:55], s79 offen nt lds
    s_waitcnt vmcnt(32)
    s_mov_b32 s79, 285696
    s_mov_b32 m0, 44032
    s_nop 0
    buffer_load_dwordx4 v8, s[52:55], s79 offen nt lds
    s_waitcnt vmcnt(32)
    v_mov_b32 v11, 120
    s_mov_b64 exec, 1
    ds_write_b32 v4, v11 offset:0
    s_mov_b64 exec, -1
    s_mov_b32 s79, 294912
    s_mov_b32 m0, 45056
    s_nop 0
    buffer_load_dwordx4 v8, s[52:55], s79 offen nt lds
    s_waitcnt vmcnt(32)
    s_mov_b32 s79, 304128
    s_mov_b32 m0, 46080
    s_nop 0
    buffer_load_dwordx4 v8, s[52:55], s79 offen nt lds
    s_waitcnt vmcnt(32)
    s_mov_b32 s79, 313344
    s_mov_b32 m0, 47104
    s_nop 0
    buffer_load_dwordx4 v8, s[52:55], s79 offen nt lds
    s_waitcnt vmcnt(32)
    s_mov_b32 s79, 322560
    s_mov_b32 m0, 48128
    s_nop 0
    buffer_load_dwordx4 v8, s[52:55], s79 offen nt lds
    s_waitcnt vmcnt(32)
    s_mov_b32 s79, 331776
    s_mov_b32 m0, 49152
    s_nop 0
    buffer_load_dwordx4 v8, s[52:55], s79 offen nt lds
    s_waitcnt vmcnt(32)
    s_mov_b32 s79, 340992
    s_mov_b32 m0, 50176
    s_nop 0
    buffer_load_dwordx4 v8, s[52:55], s79 offen nt lds
    s_waitcnt vmcnt(32)
    s_mov_b32 s79, 350208
    s_mov_b32 m0, 51200
    s_nop 0
    buffer_load_dwordx4 v8, s[52:55], s79 offen nt lds
    s_waitcnt vmcnt(32)
    s_mov_b32 s79, 359424
    s_mov_b32 m0, 52224
    s_nop 0
    buffer_load_dwordx4 v8, s[52:55], s79 offen nt lds
    s_waitcnt vmcnt(32)
    v_mov_b32 v11, 152
    s_mov_b64 exec, 1
    ds_write_b32 v4, v11 offset:0
    s_mov_b64 exec, -1
    s_mov_b32 s79, 368640
    s_mov_b32 m0, 53248
    s_nop 0
    buffer_load_dwordx4 v8, s[52:55], s79 offen nt lds
    s_waitcnt vmcnt(32)
    s_mov_b32 s79, 377856
    s_mov_b32 m0, 54272
    s_nop 0
    buffer_load_dwordx4 v8, s[52:55], s79 offen nt lds
    s_waitcnt vmcnt(32)
    s_mov_b32 s79, 387072
    s_mov_b32 m0, 55296
    s_nop 0
    buffer_load_dwordx4 v8, s[52:55], s79 offen nt lds
    s_waitcnt vmcnt(32)
    s_mov_b32 s79, 396288
    s_mov_b32 m0, 56320
    s_nop 0
    buffer_load_dwordx4 v8, s[52:55], s79 offen nt lds
    s_waitcnt vmcnt(32)
    s_mov_b32 s79, 405504
    s_mov_b32 m0, 57344
    s_nop 0
    buffer_load_dwordx4 v8, s[52:55], s79 offen nt lds
    s_waitcnt vmcnt(32)
    s_mov_b32 s79, 414720
    s_mov_b32 m0, 58368
    s_nop 0
    buffer_load_dwordx4 v8, s[52:55], s79 offen nt lds
    s_waitcnt vmcnt(32)
    s_mov_b32 s79, 423936
    s_mov_b32 m0, 59392
    s_nop 0
    buffer_load_dwordx4 v8, s[52:55], s79 offen nt lds
    s_waitcnt vmcnt(32)
    s_mov_b32 s79, 433152
    s_mov_b32 m0, 60416
    s_nop 0
    buffer_load_dwordx4 v8, s[52:55], s79 offen nt lds
    s_waitcnt vmcnt(32)
    v_mov_b32 v11, 160
    s_mov_b64 exec, 1
    ds_write_b32 v4, v11 offset:0
    s_mov_b64 exec, -1
    s_mov_b32 s79, 442368
    s_mov_b32 m0, 61440
    s_nop 0
    buffer_load_dwordx4 v8, s[52:55], s79 offen nt lds
    s_waitcnt vmcnt(32)
    s_mov_b32 s79, 451584
    s_mov_b32 m0, 62464
    s_nop 0
    buffer_load_dwordx4 v8, s[52:55], s79 offen nt lds
    s_waitcnt vmcnt(32)
    s_mov_b32 s79, 460800
    s_mov_b32 m0, 63488
    s_nop 0
    buffer_load_dwordx4 v8, s[52:55], s79 offen nt lds
    s_waitcnt vmcnt(32)
    s_mov_b32 s79, 470016
    s_mov_b32 m0, 64512
    s_nop 0
    buffer_load_dwordx4 v8, s[52:55], s79 offen nt lds
    s_waitcnt vmcnt(32)
    s_mov_b32 s79, 479232
    s_mov_b32 m0, 65536
    s_nop 0
    buffer_load_dwordx4 v8, s[52:55], s79 offen nt lds
    s_waitcnt vmcnt(32)
    s_mov_b32 s79, 488448
    s_mov_b32 m0, 66560
    s_nop 0
    buffer_load_dwordx4 v8, s[52:55], s79 offen nt lds
    s_waitcnt vmcnt(32)
    s_mov_b32 s79, 497664
    s_mov_b32 m0, 67584
    s_nop 0
    buffer_load_dwordx4 v8, s[52:55], s79 offen nt lds
    s_waitcnt vmcnt(32)
    s_mov_b32 s79, 506880
    s_mov_b32 m0, 68608
    s_nop 0
    buffer_load_dwordx4 v8, s[52:55], s79 offen nt lds
    s_waitcnt vmcnt(32)
    v_mov_b32 v11, 168
    s_mov_b64 exec, 1
    ds_write_b32 v4, v11 offset:0
    s_mov_b64 exec, -1
    s_mov_b32 s79, 516096
    s_mov_b32 m0, 69632
    s_nop 0
    buffer_load_dwordx4 v8, s[52:55], s79 offen nt lds
    s_waitcnt vmcnt(32)
    s_mov_b32 s79, 525312
    s_mov_b32 m0, 70656
    s_nop 0
    buffer_load_dwordx4 v8, s[52:55], s79 offen nt lds
    s_waitcnt vmcnt(32)
    s_mov_b32 s79, 534528
    s_mov_b32 m0, 71680
    s_nop 0
    buffer_load_dwordx4 v8, s[52:55], s79 offen nt lds
    s_waitcnt vmcnt(32)
    s_mov_b32 s79, 543744
    s_mov_b32 m0, 72704
    s_nop 0
    buffer_load_dwordx4 v8, s[52:55], s79 offen nt lds
    s_waitcnt vmcnt(32)
    s_mov_b32 s79, 552960
    s_mov_b32 m0, 73728
    s_nop 0
    buffer_load_dwordx4 v8, s[52:55], s79 offen nt lds
    s_waitcnt vmcnt(32)
    s_mov_b32 s79, 562176
    s_mov_b32 m0, 74752
    s_nop 0
    buffer_load_dwordx4 v8, s[52:55], s79 offen nt lds
    s_waitcnt vmcnt(32)
    s_mov_b32 s79, 571392
    s_mov_b32 m0, 75776
    s_nop 0
    buffer_load_dwordx4 v8, s[52:55], s79 offen nt lds
    s_waitcnt vmcnt(32)
    s_mov_b32 s79, 580608
    s_mov_b32 m0, 76800
    s_nop 0
    buffer_load_dwordx4 v8, s[52:55], s79 offen nt lds
    s_waitcnt vmcnt(32)
    v_mov_b32 v11, 176
    s_mov_b64 exec, 1
    ds_write_b32 v4, v11 offset:0
    s_mov_b64 exec, -1
    s_waitcnt vmcnt(24)
    v_mov_b32 v11, 184
    s_mov_b64 exec, 1
    ds_write_b32 v4, v11 offset:0
    s_mov_b64 exec, -1
    s_waitcnt vmcnt(16)
    v_mov_b32 v11, 192
    s_mov_b64 exec, 1
    ds_write_b32 v4, v11 offset:0
    s_mov_b64 exec, -1
    s_waitcnt vmcnt(8)
    v_mov_b32 v11, 200
    s_mov_b64 exec, 1
    ds_write_b32 v4, v11 offset:0
    s_mov_b64 exec, -1
    s_waitcnt vmcnt(0)
    v_mov_b32 v11, 208
    s_mov_b64 exec, 1
    ds_write_b32 v4, v11 offset:0
    s_mov_b64 exec, -1
Lfin:
Lend:
    s_endpgm

.section .rodata,"a"
.p2align 6
.amdhsa_kernel sequential_preLN__sliding_block_cached__moe_arch_mod__decode_kernel
  .amdhsa_next_free_vgpr 128
  .amdhsa_next_free_sgpr 102
  .amdhsa_accum_offset 128
  .amdhsa_group_segment_fixed_size 0
  .amdhsa_kernarg_size 104
  .amdhsa_user_sgpr_count 2
  .amdhsa_user_sgpr_kernarg_segment_ptr 1
  .amdhsa_system_sgpr_workgroup_id_x 1
.end_amdhsa_kernel
```
